```python
import torch

def _softmax(x, axis=-1):
    return torch.softmax(x, dim=axis)
def _gelu(x):
    return torch.nn.functional.gelu(x, approximate="tanh")
def _silu(x):
    return torch.nn.functional.silu(x)
def _sigmoid(x):
    return torch.sigmoid(x)
def _layernorm(x, axis=-1, eps=1e-5):
    m = x.mean(dim=axis, keepdim=True)
    v = x.var(dim=axis, keepdim=True, unbiased=False)
    return (x - m) / torch.sqrt(v + eps)
def _scatter_add(tgt, idx, src, axis=0):
    return tgt.clone().index_add_(axis, idx, src)
def _segment_sum(src, seg, n):
    out = torch.zeros((n,) + src.shape[1:], dtype=src.dtype)
    return out.index_add_(0, seg, src)
def _pad(x, pw):
    flat = tuple(v for pair in reversed(pw) for v in pair)
    return torch.nn.functional.pad(x, flat)

kernel_name = 'sequential_preLN__mha_block_cached__dense_activation_silu__decode'

def setup_inputs():

    _w = (lambda a: (lambda t: t.to(torch.bfloat16) if t.is_floating_point() else t)(torch.as_tensor(a)))
    def _A_setup():
        B, Sq, D = 1, 1, 512
        H, Sk, Dh = 32, 65536, 128
        return {
            "x": _w((lambda *s: torch.randn(*s, dtype=torch.bfloat16) * 0.1)(B, Sq, D)),
            "k_cache": _w((lambda *s: torch.randn(*s, dtype=torch.bfloat16) * 1.6)(B, H, Sk, Dh)),
            "v_cache": _w((lambda *s: torch.randn(*s, dtype=torch.bfloat16) * 1.6)(B, H, Sk, Dh)),
            "wq": _w((lambda *s: torch.randn(*s, dtype=torch.bfloat16) * 1.6)(D, H * Dh) * (D ** -0.5)),
            "wo": _w((lambda *s: torch.randn(*s, dtype=torch.bfloat16) * 1.6)(H * Dh, D) * ((H * Dh) ** -0.5)),
        }
    _A_in = _A_setup()

    def _B_setup():
        B, S, D, F = 1, 1, 512, 1792
        return {
            "x": _w((lambda *s: torch.randn(*s, dtype=torch.bfloat16) * 0.1)(B, S, D)),
            "w1": _w((lambda *s: torch.randn(*s, dtype=torch.bfloat16) * 3.2)(D, F) * (D ** -0.5)),
            "w2": _w((lambda *s: torch.randn(*s, dtype=torch.bfloat16) * 3.2)(F, D) * (F ** -0.5)),
        }
    _B_in = _B_setup()

    return {
        "A_x": _A_in["x"],
        "A_k_cache": _A_in["k_cache"],
        "A_v_cache": _A_in["v_cache"],
        "A_wq": _A_in["wq"],
        "A_wo": _A_in["wo"],
        "B_x": _B_in["x"],
        "B_w1": _B_in["w1"],
        "B_w2": _B_in["w2"],
    }

def reference(A_x, A_k_cache, A_v_cache, A_wq, A_wo, B_x, B_w1, B_w2):
    def _A_ref(x, k_cache, v_cache, wq, wo):
        B, Sq, D = x.shape
        H, Dh = 32, 128
        q = (lambda x, *d: x.permute(*d))((x @ wq).reshape(B, Sq, H, Dh), 0, 2, 1, 3)
        scores = torch.einsum("bhqd,bhkd->bhqk", q, k_cache) * (Dh ** -0.5)
        p = _softmax(scores, axis=-1)
        o = torch.einsum("bhqk,bhkd->bhqd", p, v_cache)
        return (lambda x, *d: x.permute(*d))(o, 0, 2, 1, 3).reshape(B, Sq, H * Dh) @ wo

    def _B_ref(x, w1, w2):
        h = torch.einsum("bsd,df->bsf", x, w1)
        h = _silu(h)
        out = torch.einsum("bsf,fd->bsd", h, w2)
        return out

    x = A_x
    h = x + _A_ref(_layernorm(x, axis=-1), A_k_cache, A_v_cache, A_wq, A_wo)
    h2 = h + _B_ref(_layernorm(h, axis=-1), B_w1, B_w2)
    return h2
```

```asm
; @launch grid=(256,1,1) block=(512,1,1) lds=143360
.amdgcn_target "amdgcn-amd-amdhsa--gfx950"
.text
.globl sequential_preLN__mha_block_cached__dense_activation_silu__decode_kernel
.p2align 8
.type sequential_preLN__mha_block_cached__dense_activation_silu__decode_kernel,@function
sequential_preLN__mha_block_cached__dense_activation_silu__decode_kernel:
    s_cmp_ge_u32 s2, 256
    s_cbranch_scc1 L_end
    v_lshrrev_b32 v1, 6, v0
    s_nop 0
    v_readfirstlane_b32 s3, v1
    v_and_b32 v0, 63, v0
    s_and_b32 s4, s2, 7
    s_lshr_b32 s5, s2, 3
    s_lshl_b32 s6, s4, 5
    s_add_u32 s6, s6, s5
    s_lshr_b32 s7, s6, 3
    s_cmp_ge_u32 s3, 4
    s_cbranch_scc1 L_helper
    s_load_dwordx4 s[40:43], s[0:1], 8
    v_lshlrev_b32 v1, 4, v0
    s_lshl_b32 s21, s3, 10
    v_add_u32 v1, s21, v1
    s_lshr_b32 s18, s5, 1
    s_and_b32 s18, s18, 7
    s_lshl_b32 s18, s18, 12
    s_and_b32 s35, s5, 7
    s_lshl_b32 s35, s35, 21
    s_mov_b32 s16, s35
    s_lshl_b32 s21, s7, 24
    s_mov_b32 s10, 0x1000000
    s_mov_b32 s11, 0x20000
    s_mov_b32 s14, 0x1000000
    s_mov_b32 s15, 0x20000
    s_waitcnt lgkmcnt(0)
    s_add_u32 s8, s40, s21
    s_addc_u32 s9, s41, 0
    s_xor_b32 s17, s16, s18
    s_add_u32 s16, s16, 4096
    buffer_load_dwordx4 v[64:67], v1, s[8:11], s17 offen nt
    s_xor_b32 s17, s16, s18
    s_add_u32 s16, s16, 4096
    buffer_load_dwordx4 v[68:71], v1, s[8:11], s17 offen nt
    s_xor_b32 s17, s16, s18
    s_add_u32 s16, s16, 4096
    buffer_load_dwordx4 v[72:75], v1, s[8:11], s17 offen nt
    s_xor_b32 s17, s16, s18
    s_add_u32 s16, s16, 4096
    buffer_load_dwordx4 v[76:79], v1, s[8:11], s17 offen nt
    s_xor_b32 s17, s16, s18
    s_add_u32 s16, s16, 4096
    buffer_load_dwordx4 v[80:83], v1, s[8:11], s17 offen nt
    s_add_u32 s12, s42, s21
    s_addc_u32 s13, s43, 0
    s_mov_b32 s20, 0x3fb8aa3b
    s_mov_b32 s22, 0x22222222
    s_mov_b32 s23, 0x22222222
    s_mov_b32 s24, 0x44444444
    s_mov_b32 s25, 0x44444444
    s_mov_b32 s26, 0x88888888
    s_mov_b32 s27, 0x88888888
    s_lshr_b32 s33, s2, 1
    s_bitcmp1_b32 s2, 0
    s_cselect_b32 s33, s33, 255
    s_cmp_lt_u32 s33, 28
    s_cselect_b32 s33, 14, 4
    v_and_b32 v2, 1, v0
    v_cmp_eq_u32 vcc, 1, v2
    v_mov_b32 v3, 0xffff
    v_mov_b32 v4, 0xffff0000
    v_cndmask_b32 v3, v3, v4, vcc
    v_bfe_u32 v2, v0, 1, 3
    v_cmp_eq_u32 vcc, 0, v2
    s_nop 1
    v_cndmask_b32 v8, 0, v3, vcc
    v_cmp_eq_u32 vcc, 1, v2
    s_nop 1
    v_cndmask_b32 v9, 0, v3, vcc
    v_cmp_eq_u32 vcc, 2, v2
    s_nop 1
    v_cndmask_b32 v10, 0, v3, vcc
    v_cmp_eq_u32 vcc, 3, v2
    s_nop 1
    v_cndmask_b32 v11, 0, v3, vcc
    v_and_b32 v2, 15, v0
    v_lshrrev_b32 v3, 4, v0
    v_lshlrev_b32 v2, 5, v2
    v_lshl_add_u32 v31, v3, 4, v2
    s_lshl_b32 s21, s3, 9
    v_add_u32 v31, s21, v31
    v_lshrrev_b32 v2, 1, v2
    s_waitcnt vmcnt(4)
    s_xor_b32 s17, s16, s18
    s_add_u32 s16, s16, 4096
    buffer_load_dwordx4 v[84:87], v1, s[8:11], s17 offen nt
    s_waitcnt vmcnt(4)
    s_xor_b32 s17, s16, s18
    s_add_u32 s16, s16, 4096
    buffer_load_dwordx4 v[88:91], v1, s[8:11], s17 offen nt
    s_waitcnt vmcnt(4)
    s_xor_b32 s17, s16, s18
    s_add_u32 s16, s16, 4096
    buffer_load_dwordx4 v[92:95], v1, s[8:11], s17 offen nt
    s_waitcnt vmcnt(4)
    s_xor_b32 s17, s16, s18
    s_add_u32 s16, s16, 4096
    buffer_load_dwordx4 v[96:99], v1, s[8:11], s17 offen nt
    s_waitcnt vmcnt(4)
    s_xor_b32 s17, s16, s18
    s_add_u32 s16, s16, 4096
    buffer_load_dwordx4 v[100:103], v1, s[8:11], s17 offen nt
    s_waitcnt vmcnt(4)
    s_xor_b32 s17, s16, s18
    s_add_u32 s16, s16, 4096
    buffer_load_dwordx4 v[104:107], v1, s[8:11], s17 offen nt
    s_waitcnt vmcnt(4)
    s_xor_b32 s17, s16, s18
    s_add_u32 s16, s16, 4096
    buffer_load_dwordx4 v[108:111], v1, s[8:11], s17 offen nt
    s_waitcnt vmcnt(4)
    s_xor_b32 s17, s16, s18
    s_add_u32 s16, s16, 4096
    buffer_load_dwordx4 v[112:115], v1, s[8:11], s17 offen nt
    s_waitcnt vmcnt(4)
    s_xor_b32 s17, s16, s18
    s_add_u32 s16, s16, 4096
    buffer_load_dwordx4 v[116:119], v1, s[8:11], s17 offen nt
    s_waitcnt vmcnt(4)
    s_xor_b32 s17, s16, s18
    s_add_u32 s16, s16, 4096
    buffer_load_dwordx4 v[120:123], v1, s[8:11], s17 offen nt
    s_waitcnt vmcnt(4)
    s_xor_b32 s17, s16, s18
    s_add_u32 s16, s16, 4096
    buffer_load_dwordx4 v[124:127], v1, s[8:11], s17 offen nt
    s_waitcnt vmcnt(4)
    s_and_b32 s16, s16, 0x1fffff
    s_lshl_b32 s34, s16, 3
    s_and_b32 s34, s34, 0xe00000
    s_xor_b32 s34, s34, s35
    s_or_b32 s16, s16, s34
    s_xor_b32 s17, s16, s18
    s_add_u32 s16, s16, 4096
    buffer_load_dwordx4 v[36:39], v1, s[8:11], s17 offen nt
    s_waitcnt vmcnt(4)
    s_xor_b32 s17, s16, s18
    s_add_u32 s16, s16, 4096
    buffer_load_dwordx4 v[40:43], v1, s[8:11], s17 offen nt
    s_waitcnt vmcnt(4)
    s_xor_b32 s17, s16, s18
    s_add_u32 s16, s16, 4096
    buffer_load_dwordx4 v[44:47], v1, s[8:11], s17 offen nt
    s_waitcnt vmcnt(4)
    s_xor_b32 s17, s16, s18
    s_add_u32 s16, s16, 4096
    buffer_load_dwordx4 v[48:51], v1, s[8:11], s17 offen nt
    s_waitcnt vmcnt(4)
    s_xor_b32 s17, s16, s18
    s_add_u32 s16, s16, 4096
    buffer_load_dwordx4 v[52:55], v1, s[8:11], s17 offen nt
    s_waitcnt vmcnt(4)
    s_xor_b32 s17, s16, s18
    s_add_u32 s16, s16, 4096
    buffer_load_dwordx4 v[56:59], v1, s[8:11], s17 offen nt
    s_waitcnt vmcnt(4)
    s_xor_b32 s17, s16, s18
    s_add_u32 s16, s16, 4096
    buffer_load_dwordx4 v[60:63], v1, s[8:11], s17 offen nt
    s_waitcnt vmcnt(4)
    s_xor_b32 s17, s16, s18
    s_add_u32 s16, s16, 4096
    buffer_load_dwordx4 v[128:131], v1, s[8:11], s17 offen nt
    s_waitcnt vmcnt(4)
    s_xor_b32 s17, s16, s18
    s_add_u32 s16, s16, 4096
    buffer_load_dwordx4 v[132:135], v1, s[8:11], s17 offen nt
    s_waitcnt vmcnt(4)
    s_xor_b32 s17, s16, s18
    s_add_u32 s16, s16, 4096
    buffer_load_dwordx4 v[136:139], v1, s[8:11], s17 offen nt
    s_waitcnt vmcnt(4)
    s_xor_b32 s17, s16, s18
    s_add_u32 s16, s16, 4096
    buffer_load_dwordx4 v[140:143], v1, s[8:11], s17 offen nt
    s_waitcnt vmcnt(4)
    s_xor_b32 s17, s16, s18
    s_add_u32 s16, s16, 4096
    buffer_load_dwordx4 v[144:147], v1, s[8:11], s17 offen nt
    s_waitcnt vmcnt(4)
    s_xor_b32 s17, s16, s18
    s_add_u32 s16, s16, 4096
    buffer_load_dwordx4 v[148:151], v1, s[8:11], s17 offen nt
    s_waitcnt vmcnt(4)
    s_xor_b32 s17, s16, s18
    s_add_u32 s16, s16, 4096
    buffer_load_dwordx4 v[152:155], v1, s[8:11], s17 offen nt
    s_waitcnt vmcnt(4)
    s_xor_b32 s17, s16, s18
    s_add_u32 s16, s16, 4096
    buffer_load_dwordx4 v[156:159], v1, s[8:11], s17 offen nt
    s_waitcnt vmcnt(4)
    s_xor_b32 s17, s16, s18
    s_add_u32 s16, s16, 4096
    buffer_load_dwordx4 v[160:163], v1, s[8:11], s17 offen nt
    s_waitcnt vmcnt(4)
    s_and_b32 s16, s16, 0x1fffff
    s_lshl_b32 s34, s16, 3
    s_and_b32 s34, s34, 0xe00000
    s_xor_b32 s34, s34, s35
    s_or_b32 s16, s16, s34
    s_xor_b32 s17, s16, s18
    s_add_u32 s16, s16, 4096
    buffer_load_dwordx4 v[164:167], v1, s[8:11], s17 offen nt
    s_waitcnt vmcnt(4)
    s_xor_b32 s17, s16, s18
    s_add_u32 s16, s16, 4096
    buffer_load_dwordx4 v[168:171], v1, s[8:11], s17 offen nt
    s_waitcnt vmcnt(4)
    s_xor_b32 s17, s16, s18
    s_add_u32 s16, s16, 4096
    buffer_load_dwordx4 v[172:175], v1, s[8:11], s17 offen nt
    s_waitcnt vmcnt(4)
    s_xor_b32 s17, s16, s18
    s_add_u32 s16, s16, 4096
    buffer_load_dwordx4 v[176:179], v1, s[8:11], s17 offen nt
    s_waitcnt vmcnt(4)
    s_xor_b32 s17, s16, s18
    s_add_u32 s16, s16, 4096
    buffer_load_dwordx4 v[180:183], v1, s[8:11], s17 offen nt
    s_waitcnt vmcnt(4)
    s_xor_b32 s17, s16, s18
    s_add_u32 s16, s16, 4096
    buffer_load_dwordx4 v[184:187], v1, s[8:11], s17 offen nt
    s_waitcnt vmcnt(4)
    s_xor_b32 s17, s16, s18
    s_add_u32 s16, s16, 4096
    buffer_load_dwordx4 v[188:191], v1, s[8:11], s17 offen nt
    s_barrier
    ds_read_b128 v[4:7], v2 offset:2048
    v_mov_b32 v29, 0xff167699
    s_waitcnt lgkmcnt(0)
    v_dot2_f32_bf16 v20, v64, v4, 0
    v_dot2_f32_bf16 v20, v65, v5, v20
    v_dot2_f32_bf16 v20, v66, v6, v20
    v_dot2_f32_bf16 v20, v67, v7, v20
    v_dot2_f32_bf16 v21, v68, v4, 0
    v_dot2_f32_bf16 v21, v69, v5, v21
    v_dot2_f32_bf16 v21, v70, v6, v21
    v_dot2_f32_bf16 v21, v71, v7, v21
    v_dot2_f32_bf16 v22, v72, v4, 0
    v_dot2_f32_bf16 v22, v73, v5, v22
    v_dot2_f32_bf16 v22, v74, v6, v22
    v_dot2_f32_bf16 v22, v75, v7, v22
    v_dot2_f32_bf16 v23, v76, v4, 0
    v_dot2_f32_bf16 v23, v77, v5, v23
    v_dot2_f32_bf16 v23, v78, v6, v23
    v_dot2_f32_bf16 v23, v79, v7, v23
    v_add_f32_dpp v24, v20, v20 row_mirror row_mask:0xf bank_mask:0x3
    v_add_f32_dpp v25, v22, v22 row_mirror row_mask:0xf bank_mask:0x3
    s_nop 0
    v_add_f32_dpp v24, v21, v21 row_mirror row_mask:0xf bank_mask:0xc
    v_add_f32_dpp v25, v23, v23 row_mirror row_mask:0xf bank_mask:0xc
    s_nop 0
    v_add_f32_dpp v26, v24, v24 row_half_mirror row_mask:0xf bank_mask:0x5
    s_nop 1
    v_add_f32_dpp v26, v25, v25 row_half_mirror row_mask:0xf bank_mask:0xa
    s_nop 1
    v_add_f32_dpp v26, v26, v26 quad_perm:[2,3,0,1] row_mask:0xf bank_mask:0xf
    s_nop 1
    v_add_f32_dpp v27, v26, v26 quad_perm:[1,0,3,2] row_mask:0xf bank_mask:0xf
    v_dot2_f32_bf16 v20, v80, v4, 0
    v_dot2_f32_bf16 v20, v81, v5, v20
    v_dot2_f32_bf16 v20, v82, v6, v20
    v_dot2_f32_bf16 v20, v83, v7, v20
    v_dot2_f32_bf16 v21, v84, v4, 0
    v_dot2_f32_bf16 v21, v85, v5, v21
    v_dot2_f32_bf16 v21, v86, v6, v21
    v_dot2_f32_bf16 v21, v87, v7, v21
    v_dot2_f32_bf16 v22, v88, v4, 0
    v_dot2_f32_bf16 v22, v89, v5, v22
    v_dot2_f32_bf16 v22, v90, v6, v22
    v_dot2_f32_bf16 v22, v91, v7, v22
    v_dot2_f32_bf16 v23, v92, v4, 0
    v_dot2_f32_bf16 v23, v93, v5, v23
    v_dot2_f32_bf16 v23, v94, v6, v23
    v_dot2_f32_bf16 v23, v95, v7, v23
    v_add_f32_dpp v24, v20, v20 row_mirror row_mask:0xf bank_mask:0x3
    v_add_f32_dpp v25, v22, v22 row_mirror row_mask:0xf bank_mask:0x3
    s_nop 0
    v_add_f32_dpp v24, v21, v21 row_mirror row_mask:0xf bank_mask:0xc
    v_add_f32_dpp v25, v23, v23 row_mirror row_mask:0xf bank_mask:0xc
    s_nop 0
    v_add_f32_dpp v26, v24, v24 row_half_mirror row_mask:0xf bank_mask:0x5
    s_nop 1
    v_add_f32_dpp v26, v25, v25 row_half_mirror row_mask:0xf bank_mask:0xa
    s_nop 1
    v_add_f32_dpp v26, v26, v26 quad_perm:[2,3,0,1] row_mask:0xf bank_mask:0xf
    s_nop 1
    v_add_f32_dpp v26, v26, v26 quad_perm:[1,0,3,2] row_mask:0xf bank_mask:0xf
    v_cndmask_b32 v27, v27, v26, s[22:23]
    s_xor_b32 s17, s16, s18
    s_add_u32 s16, s16, 4096
    buffer_load_dwordx4 v[92:95], v1, s[8:11], s17 offen nt
    v_dot2_f32_bf16 v20, v96, v4, 0
    v_dot2_f32_bf16 v20, v97, v5, v20
    v_dot2_f32_bf16 v20, v98, v6, v20
    v_dot2_f32_bf16 v20, v99, v7, v20
    v_dot2_f32_bf16 v21, v100, v4, 0
    v_dot2_f32_bf16 v21, v101, v5, v21
    v_dot2_f32_bf16 v21, v102, v6, v21
    v_dot2_f32_bf16 v21, v103, v7, v21
    v_dot2_f32_bf16 v22, v104, v4, 0
    v_dot2_f32_bf16 v22, v105, v5, v22
    v_dot2_f32_bf16 v22, v106, v6, v22
    v_dot2_f32_bf16 v22, v107, v7, v22
    v_dot2_f32_bf16 v23, v108, v4, 0
    v_dot2_f32_bf16 v23, v109, v5, v23
    v_dot2_f32_bf16 v23, v110, v6, v23
    v_dot2_f32_bf16 v23, v111, v7, v23
    v_add_f32_dpp v24, v20, v20 row_mirror row_mask:0xf bank_mask:0x3
    v_add_f32_dpp v25, v22, v22 row_mirror row_mask:0xf bank_mask:0x3
    s_nop 0
    v_add_f32_dpp v24, v21, v21 row_mirror row_mask:0xf bank_mask:0xc
    v_add_f32_dpp v25, v23, v23 row_mirror row_mask:0xf bank_mask:0xc
    s_nop 0
    v_add_f32_dpp v26, v24, v24 row_half_mirror row_mask:0xf bank_mask:0x5
    s_nop 1
    v_add_f32_dpp v26, v25, v25 row_half_mirror row_mask:0xf bank_mask:0xa
    s_nop 1
    v_add_f32_dpp v26, v26, v26 quad_perm:[2,3,0,1] row_mask:0xf bank_mask:0xf
    s_nop 1
    v_add_f32_dpp v26, v26, v26 quad_perm:[1,0,3,2] row_mask:0xf bank_mask:0xf
    v_cndmask_b32 v27, v27, v26, s[24:25]
    s_waitcnt vmcnt(5)
    s_xor_b32 s17, s16, s18
    s_add_u32 s16, s16, 4096
    buffer_load_dwordx4 v[96:99], v1, s[8:11], s17 offen nt
    v_dot2_f32_bf16 v20, v112, v4, 0
    v_dot2_f32_bf16 v20, v113, v5, v20
    v_dot2_f32_bf16 v20, v114, v6, v20
    v_dot2_f32_bf16 v20, v115, v7, v20
    v_dot2_f32_bf16 v21, v116, v4, 0
    v_dot2_f32_bf16 v21, v117, v5, v21
    v_dot2_f32_bf16 v21, v118, v6, v21
    v_dot2_f32_bf16 v21, v119, v7, v21
    v_dot2_f32_bf16 v22, v120, v4, 0
    v_dot2_f32_bf16 v22, v121, v5, v22
    v_dot2_f32_bf16 v22, v122, v6, v22
    v_dot2_f32_bf16 v22, v123, v7, v22
    v_dot2_f32_bf16 v23, v124, v4, 0
    v_dot2_f32_bf16 v23, v125, v5, v23
    v_dot2_f32_bf16 v23, v126, v6, v23
    v_dot2_f32_bf16 v23, v127, v7, v23
    v_add_f32_dpp v24, v20, v20 row_mirror row_mask:0xf bank_mask:0x3
    v_add_f32_dpp v25, v22, v22 row_mirror row_mask:0xf bank_mask:0x3
    s_nop 0
    v_add_f32_dpp v24, v21, v21 row_mirror row_mask:0xf bank_mask:0xc
    v_add_f32_dpp v25, v23, v23 row_mirror row_mask:0xf bank_mask:0xc
    s_nop 0
    v_add_f32_dpp v26, v24, v24 row_half_mirror row_mask:0xf bank_mask:0x5
    s_nop 1
    v_add_f32_dpp v26, v25, v25 row_half_mirror row_mask:0xf bank_mask:0xa
    s_nop 1
    v_add_f32_dpp v26, v26, v26 quad_perm:[2,3,0,1] row_mask:0xf bank_mask:0xf
    s_nop 1
    v_add_f32_dpp v26, v26, v26 quad_perm:[1,0,3,2] row_mask:0xf bank_mask:0xf
    v_cndmask_b32 v27, v27, v26, s[26:27]
    v_cvt_pk_bf16_f32 v27, 0, v27
    v_mul_f32 v27, 0x3db504f3, v27
    v_cvt_pk_bf16_f32 v32, 0, v27
    v_max_f32 v29, v29, v32
    s_waitcnt vmcnt(5)
    s_xor_b32 s17, s16, s18
    s_add_u32 s16, s16, 4096
    buffer_load_dwordx4 v[100:103], v1, s[8:11], s17 offen nt
    v_dot2_f32_bf16 v20, v36, v4, 0
    v_dot2_f32_bf16 v20, v37, v5, v20
    v_dot2_f32_bf16 v20, v38, v6, v20
    v_dot2_f32_bf16 v20, v39, v7, v20
    v_dot2_f32_bf16 v21, v40, v4, 0
    v_dot2_f32_bf16 v21, v41, v5, v21
    v_dot2_f32_bf16 v21, v42, v6, v21
    v_dot2_f32_bf16 v21, v43, v7, v21
    v_dot2_f32_bf16 v22, v44, v4, 0
    v_dot2_f32_bf16 v22, v45, v5, v22
    v_dot2_f32_bf16 v22, v46, v6, v22
    v_dot2_f32_bf16 v22, v47, v7, v22
    v_dot2_f32_bf16 v23, v48, v4, 0
    v_dot2_f32_bf16 v23, v49, v5, v23
    v_dot2_f32_bf16 v23, v50, v6, v23
    v_dot2_f32_bf16 v23, v51, v7, v23
    v_add_f32_dpp v24, v20, v20 row_mirror row_mask:0xf bank_mask:0x3
    v_add_f32_dpp v25, v22, v22 row_mirror row_mask:0xf bank_mask:0x3
    s_nop 0
    v_add_f32_dpp v24, v21, v21 row_mirror row_mask:0xf bank_mask:0xc
    v_add_f32_dpp v25, v23, v23 row_mirror row_mask:0xf bank_mask:0xc
    s_nop 0
    v_add_f32_dpp v26, v24, v24 row_half_mirror row_mask:0xf bank_mask:0x5
    s_nop 1
    v_add_f32_dpp v26, v25, v25 row_half_mirror row_mask:0xf bank_mask:0xa
    s_nop 1
    v_add_f32_dpp v26, v26, v26 quad_perm:[2,3,0,1] row_mask:0xf bank_mask:0xf
    s_nop 1
    v_add_f32_dpp v27, v26, v26 quad_perm:[1,0,3,2] row_mask:0xf bank_mask:0xf
    s_waitcnt vmcnt(5)
    s_xor_b32 s17, s16, s18
    s_add_u32 s16, s16, 4096
    buffer_load_dwordx4 v[104:107], v1, s[8:11], s17 offen nt
    v_dot2_f32_bf16 v20, v52, v4, 0
    v_dot2_f32_bf16 v20, v53, v5, v20
    v_dot2_f32_bf16 v20, v54, v6, v20
    v_dot2_f32_bf16 v20, v55, v7, v20
    v_dot2_f32_bf16 v21, v56, v4, 0
    v_dot2_f32_bf16 v21, v57, v5, v21
    v_dot2_f32_bf16 v21, v58, v6, v21
    v_dot2_f32_bf16 v21, v59, v7, v21
    v_dot2_f32_bf16 v22, v60, v4, 0
    v_dot2_f32_bf16 v22, v61, v5, v22
    v_dot2_f32_bf16 v22, v62, v6, v22
    v_dot2_f32_bf16 v22, v63, v7, v22
    v_dot2_f32_bf16 v23, v128, v4, 0
    v_dot2_f32_bf16 v23, v129, v5, v23
    v_dot2_f32_bf16 v23, v130, v6, v23
    v_dot2_f32_bf16 v23, v131, v7, v23
    v_add_f32_dpp v24, v20, v20 row_mirror row_mask:0xf bank_mask:0x3
    v_add_f32_dpp v25, v22, v22 row_mirror row_mask:0xf bank_mask:0x3
    s_nop 0
    v_add_f32_dpp v24, v21, v21 row_mirror row_mask:0xf bank_mask:0xc
    v_add_f32_dpp v25, v23, v23 row_mirror row_mask:0xf bank_mask:0xc
    s_nop 0
    v_add_f32_dpp v26, v24, v24 row_half_mirror row_mask:0xf bank_mask:0x5
    s_nop 1
    v_add_f32_dpp v26, v25, v25 row_half_mirror row_mask:0xf bank_mask:0xa
    s_nop 1
    v_add_f32_dpp v26, v26, v26 quad_perm:[2,3,0,1] row_mask:0xf bank_mask:0xf
    s_nop 1
    v_add_f32_dpp v26, v26, v26 quad_perm:[1,0,3,2] row_mask:0xf bank_mask:0xf
    v_cndmask_b32 v27, v27, v26, s[22:23]
    s_waitcnt vmcnt(5)
    s_xor_b32 s17, s16, s18
    s_add_u32 s16, s16, 4096
    buffer_load_dwordx4 v[108:111], v1, s[8:11], s17 offen nt
    v_dot2_f32_bf16 v20, v132, v4, 0
    v_dot2_f32_bf16 v20, v133, v5, v20
    v_dot2_f32_bf16 v20, v134, v6, v20
    v_dot2_f32_bf16 v20, v135, v7, v20
    v_dot2_f32_bf16 v21, v136, v4, 0
    v_dot2_f32_bf16 v21, v137, v5, v21
    v_dot2_f32_bf16 v21, v138, v6, v21
    v_dot2_f32_bf16 v21, v139, v7, v21
    v_dot2_f32_bf16 v22, v140, v4, 0
    v_dot2_f32_bf16 v22, v141, v5, v22
    v_dot2_f32_bf16 v22, v142, v6, v22
    v_dot2_f32_bf16 v22, v143, v7, v22
    v_dot2_f32_bf16 v23, v144, v4, 0
    v_dot2_f32_bf16 v23, v145, v5, v23
    v_dot2_f32_bf16 v23, v146, v6, v23
    v_dot2_f32_bf16 v23, v147, v7, v23
    v_add_f32_dpp v24, v20, v20 row_mirror row_mask:0xf bank_mask:0x3
    v_add_f32_dpp v25, v22, v22 row_mirror row_mask:0xf bank_mask:0x3
    s_nop 0
    v_add_f32_dpp v24, v21, v21 row_mirror row_mask:0xf bank_mask:0xc
    v_add_f32_dpp v25, v23, v23 row_mirror row_mask:0xf bank_mask:0xc
    s_nop 0
    v_add_f32_dpp v26, v24, v24 row_half_mirror row_mask:0xf bank_mask:0x5
    s_nop 1
    v_add_f32_dpp v26, v25, v25 row_half_mirror row_mask:0xf bank_mask:0xa
    s_nop 1
    v_add_f32_dpp v26, v26, v26 quad_perm:[2,3,0,1] row_mask:0xf bank_mask:0xf
    s_nop 1
    v_add_f32_dpp v26, v26, v26 quad_perm:[1,0,3,2] row_mask:0xf bank_mask:0xf
    v_cndmask_b32 v27, v27, v26, s[24:25]
    s_waitcnt vmcnt(5)
    s_xor_b32 s17, s16, s18
    s_add_u32 s16, s16, 4096
    buffer_load_dwordx4 v[112:115], v1, s[8:11], s17 offen nt
    v_dot2_f32_bf16 v20, v148, v4, 0
    v_dot2_f32_bf16 v20, v149, v5, v20
    v_dot2_f32_bf16 v20, v150, v6, v20
    v_dot2_f32_bf16 v20, v151, v7, v20
    v_dot2_f32_bf16 v21, v152, v4, 0
    v_dot2_f32_bf16 v21, v153, v5, v21
    v_dot2_f32_bf16 v21, v154, v6, v21
    v_dot2_f32_bf16 v21, v155, v7, v21
    v_dot2_f32_bf16 v22, v156, v4, 0
    v_dot2_f32_bf16 v22, v157, v5, v22
    v_dot2_f32_bf16 v22, v158, v6, v22
    v_dot2_f32_bf16 v22, v159, v7, v22
    v_dot2_f32_bf16 v23, v160, v4, 0
    v_dot2_f32_bf16 v23, v161, v5, v23
    v_dot2_f32_bf16 v23, v162, v6, v23
    v_dot2_f32_bf16 v23, v163, v7, v23
    v_add_f32_dpp v24, v20, v20 row_mirror row_mask:0xf bank_mask:0x3
    v_add_f32_dpp v25, v22, v22 row_mirror row_mask:0xf bank_mask:0x3
    s_nop 0
    v_add_f32_dpp v24, v21, v21 row_mirror row_mask:0xf bank_mask:0xc
    v_add_f32_dpp v25, v23, v23 row_mirror row_mask:0xf bank_mask:0xc
    s_nop 0
    v_add_f32_dpp v26, v24, v24 row_half_mirror row_mask:0xf bank_mask:0x5
    s_nop 1
    v_add_f32_dpp v26, v25, v25 row_half_mirror row_mask:0xf bank_mask:0xa
    s_nop 1
    v_add_f32_dpp v26, v26, v26 quad_perm:[2,3,0,1] row_mask:0xf bank_mask:0xf
    s_nop 1
    v_add_f32_dpp v26, v26, v26 quad_perm:[1,0,3,2] row_mask:0xf bank_mask:0xf
    v_cndmask_b32 v27, v27, v26, s[26:27]
    v_cvt_pk_bf16_f32 v27, 0, v27
    v_mul_f32 v27, 0x3db504f3, v27
    v_cvt_pk_bf16_f32 v33, 0, v27
    v_max_f32 v29, v29, v33
    s_waitcnt vmcnt(5)
    s_xor_b32 s17, s16, s18
    s_add_u32 s16, s16, 4096
    buffer_load_dwordx4 v[116:119], v1, s[8:11], s17 offen nt
    v_dot2_f32_bf16 v20, v164, v4, 0
    v_dot2_f32_bf16 v20, v165, v5, v20
    v_dot2_f32_bf16 v20, v166, v6, v20
    v_dot2_f32_bf16 v20, v167, v7, v20
    v_dot2_f32_bf16 v21, v168, v4, 0
    v_dot2_f32_bf16 v21, v169, v5, v21
    v_dot2_f32_bf16 v21, v170, v6, v21
    v_dot2_f32_bf16 v21, v171, v7, v21
    v_dot2_f32_bf16 v22, v172, v4, 0
    v_dot2_f32_bf16 v22, v173, v5, v22
    v_dot2_f32_bf16 v22, v174, v6, v22
    v_dot2_f32_bf16 v22, v175, v7, v22
    v_dot2_f32_bf16 v23, v176, v4, 0
    v_dot2_f32_bf16 v23, v177, v5, v23
    v_dot2_f32_bf16 v23, v178, v6, v23
    v_dot2_f32_bf16 v23, v179, v7, v23
    v_add_f32_dpp v24, v20, v20 row_mirror row_mask:0xf bank_mask:0x3
    v_add_f32_dpp v25, v22, v22 row_mirror row_mask:0xf bank_mask:0x3
    s_nop 0
    v_add_f32_dpp v24, v21, v21 row_mirror row_mask:0xf bank_mask:0xc
    v_add_f32_dpp v25, v23, v23 row_mirror row_mask:0xf bank_mask:0xc
    s_nop 0
    v_add_f32_dpp v26, v24, v24 row_half_mirror row_mask:0xf bank_mask:0x5
    s_nop 1
    v_add_f32_dpp v26, v25, v25 row_half_mirror row_mask:0xf bank_mask:0xa
    s_nop 1
    v_add_f32_dpp v26, v26, v26 quad_perm:[2,3,0,1] row_mask:0xf bank_mask:0xf
    s_nop 1
    v_add_f32_dpp v27, v26, v26 quad_perm:[1,0,3,2] row_mask:0xf bank_mask:0xf
    s_waitcnt vmcnt(5)
    s_xor_b32 s17, s16, s18
    s_add_u32 s16, s16, 4096
    buffer_load_dwordx4 v[120:123], v1, s[8:11], s17 offen nt
    v_dot2_f32_bf16 v20, v180, v4, 0
    v_dot2_f32_bf16 v20, v181, v5, v20
    v_dot2_f32_bf16 v20, v182, v6, v20
    v_dot2_f32_bf16 v20, v183, v7, v20
    v_dot2_f32_bf16 v21, v184, v4, 0
    v_dot2_f32_bf16 v21, v185, v5, v21
    v_dot2_f32_bf16 v21, v186, v6, v21
    v_dot2_f32_bf16 v21, v187, v7, v21
    v_dot2_f32_bf16 v22, v188, v4, 0
    v_dot2_f32_bf16 v22, v189, v5, v22
    v_dot2_f32_bf16 v22, v190, v6, v22
    v_dot2_f32_bf16 v22, v191, v7, v22
    s_waitcnt vmcnt(5)
    s_xor_b32 s17, s16, s18
    s_add_u32 s16, s16, 4096
    buffer_load_dwordx4 v[124:127], v1, s[8:11], s17 offen nt
    v_dot2_f32_bf16 v23, v92, v4, 0
    v_dot2_f32_bf16 v23, v93, v5, v23
    v_dot2_f32_bf16 v23, v94, v6, v23
    v_dot2_f32_bf16 v23, v95, v7, v23
    v_add_f32_dpp v24, v20, v20 row_mirror row_mask:0xf bank_mask:0x3
    v_add_f32_dpp v25, v22, v22 row_mirror row_mask:0xf bank_mask:0x3
    s_nop 0
    v_add_f32_dpp v24, v21, v21 row_mirror row_mask:0xf bank_mask:0xc
    v_add_f32_dpp v25, v23, v23 row_mirror row_mask:0xf bank_mask:0xc
    s_nop 0
    v_add_f32_dpp v26, v24, v24 row_half_mirror row_mask:0xf bank_mask:0x5
    s_nop 1
    v_add_f32_dpp v26, v25, v25 row_half_mirror row_mask:0xf bank_mask:0xa
    s_nop 1
    v_add_f32_dpp v26, v26, v26 quad_perm:[2,3,0,1] row_mask:0xf bank_mask:0xf
    s_nop 1
    v_add_f32_dpp v26, v26, v26 quad_perm:[1,0,3,2] row_mask:0xf bank_mask:0xf
    v_cndmask_b32 v27, v27, v26, s[22:23]
    s_waitcnt vmcnt(5)
    s_and_b32 s16, s16, 0x1fffff
    s_lshl_b32 s34, s16, 3
    s_and_b32 s34, s34, 0xe00000
    s_xor_b32 s34, s34, s35
    s_or_b32 s16, s16, s34
    s_xor_b32 s17, s16, s18
    s_add_u32 s16, s16, 4096
    buffer_load_dwordx4 v[64:67], v1, s[8:11], s17 offen nt
    v_dot2_f32_bf16 v20, v96, v4, 0
    v_dot2_f32_bf16 v20, v97, v5, v20
    v_dot2_f32_bf16 v20, v98, v6, v20
    v_dot2_f32_bf16 v20, v99, v7, v20
    s_waitcnt vmcnt(5)
    s_xor_b32 s17, s16, s18
    s_add_u32 s16, s16, 4096
    buffer_load_dwordx4 v[68:71], v1, s[8:11], s17 offen nt
    v_dot2_f32_bf16 v21, v100, v4, 0
    v_dot2_f32_bf16 v21, v101, v5, v21
    v_dot2_f32_bf16 v21, v102, v6, v21
    v_dot2_f32_bf16 v21, v103, v7, v21
    s_waitcnt vmcnt(5)
    s_xor_b32 s17, s16, s18
    s_add_u32 s16, s16, 4096
    buffer_load_dwordx4 v[72:75], v1, s[8:11], s17 offen nt
    v_dot2_f32_bf16 v22, v104, v4, 0
    v_dot2_f32_bf16 v22, v105, v5, v22
    v_dot2_f32_bf16 v22, v106, v6, v22
    v_dot2_f32_bf16 v22, v107, v7, v22
    s_waitcnt vmcnt(5)
    s_xor_b32 s17, s16, s18
    s_add_u32 s16, s16, 4096
    buffer_load_dwordx4 v[76:79], v1, s[8:11], s17 offen nt
    v_dot2_f32_bf16 v23, v108, v4, 0
    v_dot2_f32_bf16 v23, v109, v5, v23
    v_dot2_f32_bf16 v23, v110, v6, v23
    v_dot2_f32_bf16 v23, v111, v7, v23
    v_add_f32_dpp v24, v20, v20 row_mirror row_mask:0xf bank_mask:0x3
    v_add_f32_dpp v25, v22, v22 row_mirror row_mask:0xf bank_mask:0x3
    s_nop 0
    v_add_f32_dpp v24, v21, v21 row_mirror row_mask:0xf bank_mask:0xc
    v_add_f32_dpp v25, v23, v23 row_mirror row_mask:0xf bank_mask:0xc
    s_nop 0
    v_add_f32_dpp v26, v24, v24 row_half_mirror row_mask:0xf bank_mask:0x5
    s_nop 1
    v_add_f32_dpp v26, v25, v25 row_half_mirror row_mask:0xf bank_mask:0xa
    s_nop 1
    v_add_f32_dpp v26, v26, v26 quad_perm:[2,3,0,1] row_mask:0xf bank_mask:0xf
    s_nop 1
    v_add_f32_dpp v26, v26, v26 quad_perm:[1,0,3,2] row_mask:0xf bank_mask:0xf
    v_cndmask_b32 v27, v27, v26, s[24:25]
    s_waitcnt vmcnt(5)
    s_xor_b32 s17, s16, s18
    s_add_u32 s16, s16, 4096
    buffer_load_dwordx4 v[80:83], v1, s[8:11], s17 offen nt
    v_dot2_f32_bf16 v20, v112, v4, 0
    v_dot2_f32_bf16 v20, v113, v5, v20
    v_dot2_f32_bf16 v20, v114, v6, v20
    v_dot2_f32_bf16 v20, v115, v7, v20
    s_waitcnt vmcnt(5)
    s_xor_b32 s17, s16, s18
    s_add_u32 s16, s16, 4096
    buffer_load_dwordx4 v[84:87], v1, s[8:11], s17 offen nt
    v_dot2_f32_bf16 v21, v116, v4, 0
    v_dot2_f32_bf16 v21, v117, v5, v21
    v_dot2_f32_bf16 v21, v118, v6, v21
    v_dot2_f32_bf16 v21, v119, v7, v21
    s_waitcnt vmcnt(5)
    s_xor_b32 s17, s16, s18
    s_add_u32 s16, s16, 4096
    buffer_load_dwordx4 v[88:91], v1, s[8:11], s17 offen nt
    v_dot2_f32_bf16 v22, v120, v4, 0
    v_dot2_f32_bf16 v22, v121, v5, v22
    v_dot2_f32_bf16 v22, v122, v6, v22
    v_dot2_f32_bf16 v22, v123, v7, v22
    s_waitcnt vmcnt(5)
    s_xor_b32 s17, s16, s18
    s_add_u32 s16, s16, 4096
    buffer_load_dwordx4 v[92:95], v1, s[8:11], s17 offen nt
    v_dot2_f32_bf16 v23, v124, v4, 0
    v_dot2_f32_bf16 v23, v125, v5, v23
    v_dot2_f32_bf16 v23, v126, v6, v23
    v_dot2_f32_bf16 v23, v127, v7, v23
    v_add_f32_dpp v24, v20, v20 row_mirror row_mask:0xf bank_mask:0x3
    v_add_f32_dpp v25, v22, v22 row_mirror row_mask:0xf bank_mask:0x3
    s_nop 0
    v_add_f32_dpp v24, v21, v21 row_mirror row_mask:0xf bank_mask:0xc
    v_add_f32_dpp v25, v23, v23 row_mirror row_mask:0xf bank_mask:0xc
    s_nop 0
    v_add_f32_dpp v26, v24, v24 row_half_mirror row_mask:0xf bank_mask:0x5
    s_nop 1
    v_add_f32_dpp v26, v25, v25 row_half_mirror row_mask:0xf bank_mask:0xa
    s_nop 1
    v_add_f32_dpp v26, v26, v26 quad_perm:[2,3,0,1] row_mask:0xf bank_mask:0xf
    s_nop 1
    v_add_f32_dpp v26, v26, v26 quad_perm:[1,0,3,2] row_mask:0xf bank_mask:0xf
    v_cndmask_b32 v27, v27, v26, s[26:27]
    v_cvt_pk_bf16_f32 v27, 0, v27
    v_mul_f32 v27, 0x3db504f3, v27
    v_cvt_pk_bf16_f32 v34, 0, v27
    v_max_f32 v29, v29, v34
    s_mov_b32 s19, 3
L_kearly:
    s_waitcnt vmcnt(5)
    s_xor_b32 s17, s16, s18
    s_add_u32 s16, s16, 4096
    buffer_load_dwordx4 v[96:99], v1, s[8:11], s17 offen nt
    v_dot2_f32_bf16 v20, v64, v4, 0
    v_dot2_f32_bf16 v20, v65, v5, v20
    v_dot2_f32_bf16 v20, v66, v6, v20
    v_dot2_f32_bf16 v20, v67, v7, v20
    s_waitcnt vmcnt(5)
    s_xor_b32 s17, s16, s18
    s_add_u32 s16, s16, 4096
    buffer_load_dwordx4 v[100:103], v1, s[8:11], s17 offen nt
    v_dot2_f32_bf16 v21, v68, v4, 0
    v_dot2_f32_bf16 v21, v69, v5, v21
    v_dot2_f32_bf16 v21, v70, v6, v21
    v_dot2_f32_bf16 v21, v71, v7, v21
    s_waitcnt vmcnt(5)
    s_xor_b32 s17, s16, s18
    s_add_u32 s16, s16, 4096
    buffer_load_dwordx4 v[104:107], v1, s[8:11], s17 offen nt
    v_dot2_f32_bf16 v22, v72, v4, 0
    v_dot2_f32_bf16 v22, v73, v5, v22
    v_dot2_f32_bf16 v22, v74, v6, v22
    v_dot2_f32_bf16 v22, v75, v7, v22
    s_waitcnt vmcnt(5)
    s_xor_b32 s17, s16, s18
    s_add_u32 s16, s16, 4096
    buffer_load_dwordx4 v[108:111], v1, s[8:11], s17 offen nt
    v_dot2_f32_bf16 v23, v76, v4, 0
    v_dot2_f32_bf16 v23, v77, v5, v23
    v_dot2_f32_bf16 v23, v78, v6, v23
    v_dot2_f32_bf16 v23, v79, v7, v23
    v_add_f32_dpp v24, v20, v20 row_mirror row_mask:0xf bank_mask:0x3
    v_add_f32_dpp v25, v22, v22 row_mirror row_mask:0xf bank_mask:0x3
    s_nop 0
    v_add_f32_dpp v24, v21, v21 row_mirror row_mask:0xf bank_mask:0xc
    v_add_f32_dpp v25, v23, v23 row_mirror row_mask:0xf bank_mask:0xc
    s_nop 0
    v_add_f32_dpp v26, v24, v24 row_half_mirror row_mask:0xf bank_mask:0x5
    s_nop 1
    v_add_f32_dpp v26, v25, v25 row_half_mirror row_mask:0xf bank_mask:0xa
    s_nop 1
    v_add_f32_dpp v26, v26, v26 quad_perm:[2,3,0,1] row_mask:0xf bank_mask:0xf
    s_nop 1
    v_add_f32_dpp v27, v26, v26 quad_perm:[1,0,3,2] row_mask:0xf bank_mask:0xf
    s_waitcnt vmcnt(5)
    s_xor_b32 s17, s16, s18
    s_add_u32 s16, s16, 4096
    buffer_load_dwordx4 v[112:115], v1, s[8:11], s17 offen nt
    v_dot2_f32_bf16 v20, v80, v4, 0
    v_dot2_f32_bf16 v20, v81, v5, v20
    v_dot2_f32_bf16 v20, v82, v6, v20
    v_dot2_f32_bf16 v20, v83, v7, v20
    s_waitcnt vmcnt(5)
    s_xor_b32 s17, s16, s18
    s_add_u32 s16, s16, 4096
    buffer_load_dwordx4 v[116:119], v1, s[8:11], s17 offen nt
    v_dot2_f32_bf16 v21, v84, v4, 0
    v_dot2_f32_bf16 v21, v85, v5, v21
    v_dot2_f32_bf16 v21, v86, v6, v21
    v_dot2_f32_bf16 v21, v87, v7, v21
    s_waitcnt vmcnt(5)
    s_xor_b32 s17, s16, s18
    s_add_u32 s16, s16, 4096
    buffer_load_dwordx4 v[120:123], v1, s[8:11], s17 offen nt
    v_dot2_f32_bf16 v22, v88, v4, 0
    v_dot2_f32_bf16 v22, v89, v5, v22
    v_dot2_f32_bf16 v22, v90, v6, v22
    v_dot2_f32_bf16 v22, v91, v7, v22
    s_waitcnt vmcnt(5)
    s_xor_b32 s17, s16, s18
    s_add_u32 s16, s16, 4096
    buffer_load_dwordx4 v[124:127], v1, s[8:11], s17 offen nt
    v_dot2_f32_bf16 v23, v92, v4, 0
    v_dot2_f32_bf16 v23, v93, v5, v23
    v_dot2_f32_bf16 v23, v94, v6, v23
    v_dot2_f32_bf16 v23, v95, v7, v23
    v_add_f32_dpp v24, v20, v20 row_mirror row_mask:0xf bank_mask:0x3
    v_add_f32_dpp v25, v22, v22 row_mirror row_mask:0xf bank_mask:0x3
    s_nop 0
    v_add_f32_dpp v24, v21, v21 row_mirror row_mask:0xf bank_mask:0xc
    v_add_f32_dpp v25, v23, v23 row_mirror row_mask:0xf bank_mask:0xc
    s_nop 0
    v_add_f32_dpp v26, v24, v24 row_half_mirror row_mask:0xf bank_mask:0x5
    s_nop 1
    v_add_f32_dpp v26, v25, v25 row_half_mirror row_mask:0xf bank_mask:0xa
    s_nop 1
    v_add_f32_dpp v26, v26, v26 quad_perm:[2,3,0,1] row_mask:0xf bank_mask:0xf
    s_nop 1
    v_add_f32_dpp v26, v26, v26 quad_perm:[1,0,3,2] row_mask:0xf bank_mask:0xf
    v_cndmask_b32 v27, v27, v26, s[22:23]
    s_waitcnt vmcnt(5)
    s_and_b32 s16, s16, 0x1fffff
    s_lshl_b32 s34, s16, 3
    s_and_b32 s34, s34, 0xe00000
    s_xor_b32 s34, s34, s35
    s_or_b32 s16, s16, s34
    s_xor_b32 s17, s16, s18
    s_add_u32 s16, s16, 4096
    buffer_load_dwordx4 v[64:67], v1, s[8:11], s17 offen nt
    v_dot2_f32_bf16 v20, v96, v4, 0
    v_dot2_f32_bf16 v20, v97, v5, v20
    v_dot2_f32_bf16 v20, v98, v6, v20
    v_dot2_f32_bf16 v20, v99, v7, v20
    s_waitcnt vmcnt(5)
    s_xor_b32 s17, s16, s18
    s_add_u32 s16, s16, 4096
    buffer_load_dwordx4 v[68:71], v1, s[8:11], s17 offen nt
    v_dot2_f32_bf16 v21, v100, v4, 0
    v_dot2_f32_bf16 v21, v101, v5, v21
    v_dot2_f32_bf16 v21, v102, v6, v21
    v_dot2_f32_bf16 v21, v103, v7, v21
    s_waitcnt vmcnt(5)
    s_xor_b32 s17, s16, s18
    s_add_u32 s16, s16, 4096
    buffer_load_dwordx4 v[72:75], v1, s[8:11], s17 offen nt
    v_dot2_f32_bf16 v22, v104, v4, 0
    v_dot2_f32_bf16 v22, v105, v5, v22
    v_dot2_f32_bf16 v22, v106, v6, v22
    v_dot2_f32_bf16 v22, v107, v7, v22
    s_waitcnt vmcnt(5)
    s_xor_b32 s17, s16, s18
    s_add_u32 s16, s16, 4096
    buffer_load_dwordx4 v[76:79], v1, s[8:11], s17 offen nt
    v_dot2_f32_bf16 v23, v108, v4, 0
    v_dot2_f32_bf16 v23, v109, v5, v23
    v_dot2_f32_bf16 v23, v110, v6, v23
    v_dot2_f32_bf16 v23, v111, v7, v23
    v_add_f32_dpp v24, v20, v20 row_mirror row_mask:0xf bank_mask:0x3
    v_add_f32_dpp v25, v22, v22 row_mirror row_mask:0xf bank_mask:0x3
    s_nop 0
    v_add_f32_dpp v24, v21, v21 row_mirror row_mask:0xf bank_mask:0xc
    v_add_f32_dpp v25, v23, v23 row_mirror row_mask:0xf bank_mask:0xc
    s_nop 0
    v_add_f32_dpp v26, v24, v24 row_half_mirror row_mask:0xf bank_mask:0x5
    s_nop 1
    v_add_f32_dpp v26, v25, v25 row_half_mirror row_mask:0xf bank_mask:0xa
    s_nop 1
    v_add_f32_dpp v26, v26, v26 quad_perm:[2,3,0,1] row_mask:0xf bank_mask:0xf
    s_nop 1
    v_add_f32_dpp v26, v26, v26 quad_perm:[1,0,3,2] row_mask:0xf bank_mask:0xf
    v_cndmask_b32 v27, v27, v26, s[24:25]
    s_waitcnt vmcnt(5)
    s_xor_b32 s17, s16, s18
    s_add_u32 s16, s16, 4096
    buffer_load_dwordx4 v[80:83], v1, s[8:11], s17 offen nt
    v_dot2_f32_bf16 v20, v112, v4, 0
    v_dot2_f32_bf16 v20, v113, v5, v20
    v_dot2_f32_bf16 v20, v114, v6, v20
    v_dot2_f32_bf16 v20, v115, v7, v20
    s_waitcnt vmcnt(5)
    s_xor_b32 s17, s16, s18
    s_add_u32 s16, s16, 4096
    buffer_load_dwordx4 v[84:87], v1, s[8:11], s17 offen nt
    v_dot2_f32_bf16 v21, v116, v4, 0
    v_dot2_f32_bf16 v21, v117, v5, v21
    v_dot2_f32_bf16 v21, v118, v6, v21
    v_dot2_f32_bf16 v21, v119, v7, v21
    s_waitcnt vmcnt(5)
    s_xor_b32 s17, s16, s18
    s_add_u32 s16, s16, 4096
    buffer_load_dwordx4 v[88:91], v1, s[8:11], s17 offen nt
    v_dot2_f32_bf16 v22, v120, v4, 0
    v_dot2_f32_bf16 v22, v121, v5, v22
    v_dot2_f32_bf16 v22, v122, v6, v22
    v_dot2_f32_bf16 v22, v123, v7, v22
    s_waitcnt vmcnt(5)
    s_xor_b32 s17, s16, s18
    s_add_u32 s16, s16, 4096
    buffer_load_dwordx4 v[92:95], v1, s[8:11], s17 offen nt
    v_dot2_f32_bf16 v23, v124, v4, 0
    v_dot2_f32_bf16 v23, v125, v5, v23
    v_dot2_f32_bf16 v23, v126, v6, v23
    v_dot2_f32_bf16 v23, v127, v7, v23
    v_add_f32_dpp v24, v20, v20 row_mirror row_mask:0xf bank_mask:0x3
    v_add_f32_dpp v25, v22, v22 row_mirror row_mask:0xf bank_mask:0x3
    s_nop 0
    v_add_f32_dpp v24, v21, v21 row_mirror row_mask:0xf bank_mask:0xc
    v_add_f32_dpp v25, v23, v23 row_mirror row_mask:0xf bank_mask:0xc
    s_nop 0
    v_add_f32_dpp v26, v24, v24 row_half_mirror row_mask:0xf bank_mask:0x5
    s_nop 1
    v_add_f32_dpp v26, v25, v25 row_half_mirror row_mask:0xf bank_mask:0xa
    s_nop 1
    v_add_f32_dpp v26, v26, v26 quad_perm:[2,3,0,1] row_mask:0xf bank_mask:0xf
    s_nop 1
    v_add_f32_dpp v26, v26, v26 quad_perm:[1,0,3,2] row_mask:0xf bank_mask:0xf
    v_cndmask_b32 v27, v27, v26, s[26:27]
    v_cvt_pk_bf16_f32 v27, 0, v27
    v_mul_f32 v27, 0x3db504f3, v27
    v_cvt_pk_bf16_f32 v27, 0, v27
    s_set_gpr_idx_on s19, gpr_idx(DST)
    s_nop 0
    v_mov_b32 v32, v27
    s_set_gpr_idx_off
    v_max_f32 v29, v29, v27
    s_add_u32 s19, s19, 1
    s_cmp_lg_u32 s19, s33
    s_cbranch_scc1 L_kearly
L_kloop:
    s_waitcnt vmcnt(4)
    s_xor_b32 s17, s16, s18
    s_add_u32 s16, s16, 4096
    buffer_load_dwordx4 v[96:99], v1, s[8:11], s17 offen nt
    v_dot2_f32_bf16 v20, v64, v4, 0
    v_dot2_f32_bf16 v20, v65, v5, v20
    v_dot2_f32_bf16 v20, v66, v6, v20
    v_dot2_f32_bf16 v20, v67, v7, v20
    s_waitcnt vmcnt(4)
    s_xor_b32 s17, s16, s18
    s_add_u32 s16, s16, 4096
    buffer_load_dwordx4 v[100:103], v1, s[8:11], s17 offen nt
    v_dot2_f32_bf16 v21, v68, v4, 0
    v_dot2_f32_bf16 v21, v69, v5, v21
    v_dot2_f32_bf16 v21, v70, v6, v21
    v_dot2_f32_bf16 v21, v71, v7, v21
    s_waitcnt vmcnt(4)
    s_xor_b32 s17, s16, s18
    s_add_u32 s16, s16, 4096
    buffer_load_dwordx4 v[104:107], v1, s[8:11], s17 offen nt
    v_dot2_f32_bf16 v22, v72, v4, 0
    v_dot2_f32_bf16 v22, v73, v5, v22
    v_dot2_f32_bf16 v22, v74, v6, v22
    v_dot2_f32_bf16 v22, v75, v7, v22
    s_waitcnt vmcnt(4)
    s_xor_b32 s17, s16, s18
    s_add_u32 s16, s16, 4096
    buffer_load_dwordx4 v[108:111], v1, s[8:11], s17 offen nt
    v_dot2_f32_bf16 v23, v76, v4, 0
    v_dot2_f32_bf16 v23, v77, v5, v23
    v_dot2_f32_bf16 v23, v78, v6, v23
    v_dot2_f32_bf16 v23, v79, v7, v23
    v_add_f32_dpp v24, v20, v20 row_mirror row_mask:0xf bank_mask:0x3
    v_add_f32_dpp v25, v22, v22 row_mirror row_mask:0xf bank_mask:0x3
    s_nop 0
    v_add_f32_dpp v24, v21, v21 row_mirror row_mask:0xf bank_mask:0xc
    v_add_f32_dpp v25, v23, v23 row_mirror row_mask:0xf bank_mask:0xc
    s_nop 0
    v_add_f32_dpp v26, v24, v24 row_half_mirror row_mask:0xf bank_mask:0x5
    s_nop 1
    v_add_f32_dpp v26, v25, v25 row_half_mirror row_mask:0xf bank_mask:0xa
    s_nop 1
    v_add_f32_dpp v26, v26, v26 quad_perm:[2,3,0,1] row_mask:0xf bank_mask:0xf
    s_nop 1
    v_add_f32_dpp v27, v26, v26 quad_perm:[1,0,3,2] row_mask:0xf bank_mask:0xf
    s_waitcnt vmcnt(4)
    s_xor_b32 s17, s16, s18
    s_add_u32 s16, s16, 4096
    buffer_load_dwordx4 v[112:115], v1, s[8:11], s17 offen nt
    v_dot2_f32_bf16 v20, v80, v4, 0
    v_dot2_f32_bf16 v20, v81, v5, v20
    v_dot2_f32_bf16 v20, v82, v6, v20
    v_dot2_f32_bf16 v20, v83, v7, v20
    s_waitcnt vmcnt(4)
    s_xor_b32 s17, s16, s18
    s_add_u32 s16, s16, 4096
    buffer_load_dwordx4 v[116:119], v1, s[8:11], s17 offen nt
    v_dot2_f32_bf16 v21, v84, v4, 0
    v_dot2_f32_bf16 v21, v85, v5, v21
    v_dot2_f32_bf16 v21, v86, v6, v21
    v_dot2_f32_bf16 v21, v87, v7, v21
    s_waitcnt vmcnt(4)
    s_xor_b32 s17, s16, s18
    s_add_u32 s16, s16, 4096
    buffer_load_dwordx4 v[120:123], v1, s[8:11], s17 offen nt
    v_dot2_f32_bf16 v22, v88, v4, 0
    v_dot2_f32_bf16 v22, v89, v5, v22
    v_dot2_f32_bf16 v22, v90, v6, v22
    v_dot2_f32_bf16 v22, v91, v7, v22
    s_waitcnt vmcnt(4)
    s_xor_b32 s17, s16, s18
    s_add_u32 s16, s16, 4096
    buffer_load_dwordx4 v[124:127], v1, s[8:11], s17 offen nt
    v_dot2_f32_bf16 v23, v92, v4, 0
    v_dot2_f32_bf16 v23, v93, v5, v23
    v_dot2_f32_bf16 v23, v94, v6, v23
    v_dot2_f32_bf16 v23, v95, v7, v23
    v_add_f32_dpp v24, v20, v20 row_mirror row_mask:0xf bank_mask:0x3
    v_add_f32_dpp v25, v22, v22 row_mirror row_mask:0xf bank_mask:0x3
    s_nop 0
    v_add_f32_dpp v24, v21, v21 row_mirror row_mask:0xf bank_mask:0xc
    v_add_f32_dpp v25, v23, v23 row_mirror row_mask:0xf bank_mask:0xc
    s_nop 0
    v_add_f32_dpp v26, v24, v24 row_half_mirror row_mask:0xf bank_mask:0x5
    s_nop 1
    v_add_f32_dpp v26, v25, v25 row_half_mirror row_mask:0xf bank_mask:0xa
    s_nop 1
    v_add_f32_dpp v26, v26, v26 quad_perm:[2,3,0,1] row_mask:0xf bank_mask:0xf
    s_nop 1
    v_add_f32_dpp v26, v26, v26 quad_perm:[1,0,3,2] row_mask:0xf bank_mask:0xf
    v_cndmask_b32 v27, v27, v26, s[22:23]
    s_waitcnt vmcnt(4)
    s_and_b32 s16, s16, 0x1fffff
    s_lshl_b32 s34, s16, 3
    s_and_b32 s34, s34, 0xe00000
    s_xor_b32 s34, s34, s35
    s_or_b32 s16, s16, s34
    s_xor_b32 s17, s16, s18
    s_add_u32 s16, s16, 4096
    buffer_load_dwordx4 v[64:67], v1, s[8:11], s17 offen nt
    v_dot2_f32_bf16 v20, v96, v4, 0
    v_dot2_f32_bf16 v20, v97, v5, v20
    v_dot2_f32_bf16 v20, v98, v6, v20
    v_dot2_f32_bf16 v20, v99, v7, v20
    s_waitcnt vmcnt(4)
    s_xor_b32 s17, s16, s18
    s_add_u32 s16, s16, 4096
    buffer_load_dwordx4 v[68:71], v1, s[8:11], s17 offen nt
    v_dot2_f32_bf16 v21, v100, v4, 0
    v_dot2_f32_bf16 v21, v101, v5, v21
    v_dot2_f32_bf16 v21, v102, v6, v21
    v_dot2_f32_bf16 v21, v103, v7, v21
    s_waitcnt vmcnt(4)
    s_xor_b32 s17, s16, s18
    s_add_u32 s16, s16, 4096
    buffer_load_dwordx4 v[72:75], v1, s[8:11], s17 offen nt
    v_dot2_f32_bf16 v22, v104, v4, 0
    v_dot2_f32_bf16 v22, v105, v5, v22
    v_dot2_f32_bf16 v22, v106, v6, v22
    v_dot2_f32_bf16 v22, v107, v7, v22
    s_waitcnt vmcnt(4)
    s_xor_b32 s17, s16, s18
    s_add_u32 s16, s16, 4096
    buffer_load_dwordx4 v[76:79], v1, s[8:11], s17 offen nt
    v_dot2_f32_bf16 v23, v108, v4, 0
    v_dot2_f32_bf16 v23, v109, v5, v23
    v_dot2_f32_bf16 v23, v110, v6, v23
    v_dot2_f32_bf16 v23, v111, v7, v23
    v_add_f32_dpp v24, v20, v20 row_mirror row_mask:0xf bank_mask:0x3
    v_add_f32_dpp v25, v22, v22 row_mirror row_mask:0xf bank_mask:0x3
    s_nop 0
    v_add_f32_dpp v24, v21, v21 row_mirror row_mask:0xf bank_mask:0xc
    v_add_f32_dpp v25, v23, v23 row_mirror row_mask:0xf bank_mask:0xc
    s_nop 0
    v_add_f32_dpp v26, v24, v24 row_half_mirror row_mask:0xf bank_mask:0x5
    s_nop 1
    v_add_f32_dpp v26, v25, v25 row_half_mirror row_mask:0xf bank_mask:0xa
    s_nop 1
    v_add_f32_dpp v26, v26, v26 quad_perm:[2,3,0,1] row_mask:0xf bank_mask:0xf
    s_nop 1
    v_add_f32_dpp v26, v26, v26 quad_perm:[1,0,3,2] row_mask:0xf bank_mask:0xf
    v_cndmask_b32 v27, v27, v26, s[24:25]
    s_waitcnt vmcnt(4)
    s_xor_b32 s17, s16, s18
    s_add_u32 s16, s16, 4096
    buffer_load_dwordx4 v[80:83], v1, s[8:11], s17 offen nt
    v_dot2_f32_bf16 v20, v112, v4, 0
    v_dot2_f32_bf16 v20, v113, v5, v20
    v_dot2_f32_bf16 v20, v114, v6, v20
    v_dot2_f32_bf16 v20, v115, v7, v20
    s_waitcnt vmcnt(4)
    s_xor_b32 s17, s16, s18
    s_add_u32 s16, s16, 4096
    buffer_load_dwordx4 v[84:87], v1, s[8:11], s17 offen nt
    v_dot2_f32_bf16 v21, v116, v4, 0
    v_dot2_f32_bf16 v21, v117, v5, v21
    v_dot2_f32_bf16 v21, v118, v6, v21
    v_dot2_f32_bf16 v21, v119, v7, v21
    s_waitcnt vmcnt(4)
    s_xor_b32 s17, s16, s18
    s_add_u32 s16, s16, 4096
    buffer_load_dwordx4 v[88:91], v1, s[8:11], s17 offen nt
    v_dot2_f32_bf16 v22, v120, v4, 0
    v_dot2_f32_bf16 v22, v121, v5, v22
    v_dot2_f32_bf16 v22, v122, v6, v22
    v_dot2_f32_bf16 v22, v123, v7, v22
    s_waitcnt vmcnt(4)
    s_xor_b32 s17, s16, s18
    s_add_u32 s16, s16, 4096
    buffer_load_dwordx4 v[92:95], v1, s[8:11], s17 offen nt
    v_dot2_f32_bf16 v23, v124, v4, 0
    v_dot2_f32_bf16 v23, v125, v5, v23
    v_dot2_f32_bf16 v23, v126, v6, v23
    v_dot2_f32_bf16 v23, v127, v7, v23
    v_add_f32_dpp v24, v20, v20 row_mirror row_mask:0xf bank_mask:0x3
    v_add_f32_dpp v25, v22, v22 row_mirror row_mask:0xf bank_mask:0x3
    s_nop 0
    v_add_f32_dpp v24, v21, v21 row_mirror row_mask:0xf bank_mask:0xc
    v_add_f32_dpp v25, v23, v23 row_mirror row_mask:0xf bank_mask:0xc
    s_nop 0
    v_add_f32_dpp v26, v24, v24 row_half_mirror row_mask:0xf bank_mask:0x5
    s_nop 1
    v_add_f32_dpp v26, v25, v25 row_half_mirror row_mask:0xf bank_mask:0xa
    s_nop 1
    v_add_f32_dpp v26, v26, v26 quad_perm:[2,3,0,1] row_mask:0xf bank_mask:0xf
    s_nop 1
    v_add_f32_dpp v26, v26, v26 quad_perm:[1,0,3,2] row_mask:0xf bank_mask:0xf
    v_cndmask_b32 v27, v27, v26, s[26:27]
    v_cvt_pk_bf16_f32 v27, 0, v27
    v_mul_f32 v27, 0x3db504f3, v27
    v_cvt_pk_bf16_f32 v27, 0, v27
    s_set_gpr_idx_on s19, gpr_idx(DST)
    s_nop 0
    v_mov_b32 v32, v27
    s_set_gpr_idx_off
    v_max_f32 v29, v29, v27
    s_add_u32 s19, s19, 1
    s_cmp_lg_u32 s19, 31
    s_cbranch_scc1 L_kloop
    s_waitcnt vmcnt(4)
    s_xor_b32 s17, s16, s18
    s_add_u32 s16, s16, 4096
    buffer_load_dwordx4 v[96:99], v1, s[8:11], s17 offen nt
    v_dot2_f32_bf16 v20, v64, v4, 0
    v_dot2_f32_bf16 v20, v65, v5, v20
    v_dot2_f32_bf16 v20, v66, v6, v20
    v_dot2_f32_bf16 v20, v67, v7, v20
    s_waitcnt vmcnt(4)
    s_xor_b32 s17, s16, s18
    s_add_u32 s16, s16, 4096
    buffer_load_dwordx4 v[100:103], v1, s[8:11], s17 offen nt
    v_dot2_f32_bf16 v21, v68, v4, 0
    v_dot2_f32_bf16 v21, v69, v5, v21
    v_dot2_f32_bf16 v21, v70, v6, v21
    v_dot2_f32_bf16 v21, v71, v7, v21
    s_waitcnt vmcnt(4)
    s_xor_b32 s17, s16, s18
    s_add_u32 s16, s16, 4096
    buffer_load_dwordx4 v[104:107], v1, s[8:11], s17 offen nt
    v_dot2_f32_bf16 v22, v72, v4, 0
    v_dot2_f32_bf16 v22, v73, v5, v22
    v_dot2_f32_bf16 v22, v74, v6, v22
    v_dot2_f32_bf16 v22, v75, v7, v22
    s_waitcnt vmcnt(4)
    s_xor_b32 s17, s16, s18
    s_add_u32 s16, s16, 4096
    buffer_load_dwordx4 v[108:111], v1, s[8:11], s17 offen nt
    v_dot2_f32_bf16 v23, v76, v4, 0
    v_dot2_f32_bf16 v23, v77, v5, v23
    v_dot2_f32_bf16 v23, v78, v6, v23
    v_dot2_f32_bf16 v23, v79, v7, v23
    v_add_f32_dpp v24, v20, v20 row_mirror row_mask:0xf bank_mask:0x3
    v_add_f32_dpp v25, v22, v22 row_mirror row_mask:0xf bank_mask:0x3
    s_nop 0
    v_add_f32_dpp v24, v21, v21 row_mirror row_mask:0xf bank_mask:0xc
    v_add_f32_dpp v25, v23, v23 row_mirror row_mask:0xf bank_mask:0xc
    s_nop 0
    v_add_f32_dpp v26, v24, v24 row_half_mirror row_mask:0xf bank_mask:0x5
    s_nop 1
    v_add_f32_dpp v26, v25, v25 row_half_mirror row_mask:0xf bank_mask:0xa
    s_nop 1
    v_add_f32_dpp v26, v26, v26 quad_perm:[2,3,0,1] row_mask:0xf bank_mask:0xf
    s_nop 1
    v_add_f32_dpp v27, v26, v26 quad_perm:[1,0,3,2] row_mask:0xf bank_mask:0xf
    s_waitcnt vmcnt(4)
    s_xor_b32 s17, s16, s18
    s_add_u32 s16, s16, 4096
    buffer_load_dwordx4 v[112:115], v1, s[8:11], s17 offen nt
    v_dot2_f32_bf16 v20, v80, v4, 0
    v_dot2_f32_bf16 v20, v81, v5, v20
    v_dot2_f32_bf16 v20, v82, v6, v20
    v_dot2_f32_bf16 v20, v83, v7, v20
    s_waitcnt vmcnt(4)
    s_xor_b32 s17, s16, s18
    s_add_u32 s16, s16, 4096
    buffer_load_dwordx4 v[116:119], v1, s[8:11], s17 offen nt
    v_dot2_f32_bf16 v21, v84, v4, 0
    v_dot2_f32_bf16 v21, v85, v5, v21
    v_dot2_f32_bf16 v21, v86, v6, v21
    v_dot2_f32_bf16 v21, v87, v7, v21
    s_waitcnt vmcnt(4)
    s_xor_b32 s17, s16, s18
    s_add_u32 s16, s16, 4096
    buffer_load_dwordx4 v[120:123], v1, s[8:11], s17 offen nt
    v_dot2_f32_bf16 v22, v88, v4, 0
    v_dot2_f32_bf16 v22, v89, v5, v22
    v_dot2_f32_bf16 v22, v90, v6, v22
    v_dot2_f32_bf16 v22, v91, v7, v22
    s_waitcnt vmcnt(4)
    s_xor_b32 s17, s16, s18
    s_add_u32 s16, s16, 4096
    buffer_load_dwordx4 v[124:127], v1, s[8:11], s17 offen nt
    v_dot2_f32_bf16 v23, v92, v4, 0
    v_dot2_f32_bf16 v23, v93, v5, v23
    v_dot2_f32_bf16 v23, v94, v6, v23
    v_dot2_f32_bf16 v23, v95, v7, v23
    v_add_f32_dpp v24, v20, v20 row_mirror row_mask:0xf bank_mask:0x3
    v_add_f32_dpp v25, v22, v22 row_mirror row_mask:0xf bank_mask:0x3
    s_nop 0
    v_add_f32_dpp v24, v21, v21 row_mirror row_mask:0xf bank_mask:0xc
    v_add_f32_dpp v25, v23, v23 row_mirror row_mask:0xf bank_mask:0xc
    s_nop 0
    v_add_f32_dpp v26, v24, v24 row_half_mirror row_mask:0xf bank_mask:0x5
    s_nop 1
    v_add_f32_dpp v26, v25, v25 row_half_mirror row_mask:0xf bank_mask:0xa
    s_nop 1
    v_add_f32_dpp v26, v26, v26 quad_perm:[2,3,0,1] row_mask:0xf bank_mask:0xf
    s_nop 1
    v_add_f32_dpp v26, v26, v26 quad_perm:[1,0,3,2] row_mask:0xf bank_mask:0xf
    v_cndmask_b32 v27, v27, v26, s[22:23]
    s_waitcnt vmcnt(4)
    s_mov_b32 s16, s35
    s_xor_b32 s17, s16, s18
    s_add_u32 s16, s16, 4096
    buffer_load_dwordx4 v[64:67], v1, s[12:15], s17 offen nt
    v_dot2_f32_bf16 v20, v96, v4, 0
    v_dot2_f32_bf16 v20, v97, v5, v20
    v_dot2_f32_bf16 v20, v98, v6, v20
    v_dot2_f32_bf16 v20, v99, v7, v20
    s_waitcnt vmcnt(4)
    s_xor_b32 s17, s16, s18
    s_add_u32 s16, s16, 4096
    buffer_load_dwordx4 v[68:71], v1, s[12:15], s17 offen nt
    v_dot2_f32_bf16 v21, v100, v4, 0
    v_dot2_f32_bf16 v21, v101, v5, v21
    v_dot2_f32_bf16 v21, v102, v6, v21
    v_dot2_f32_bf16 v21, v103, v7, v21
    s_waitcnt vmcnt(4)
    s_xor_b32 s17, s16, s18
    s_add_u32 s16, s16, 4096
    buffer_load_dwordx4 v[72:75], v1, s[12:15], s17 offen nt
    v_dot2_f32_bf16 v22, v104, v4, 0
    v_dot2_f32_bf16 v22, v105, v5, v22
    v_dot2_f32_bf16 v22, v106, v6, v22
    v_dot2_f32_bf16 v22, v107, v7, v22
    s_waitcnt vmcnt(4)
    s_xor_b32 s17, s16, s18
    s_add_u32 s16, s16, 4096
    buffer_load_dwordx4 v[76:79], v1, s[12:15], s17 offen nt
    v_dot2_f32_bf16 v23, v108, v4, 0
    v_dot2_f32_bf16 v23, v109, v5, v23
    v_dot2_f32_bf16 v23, v110, v6, v23
    v_dot2_f32_bf16 v23, v111, v7, v23
    v_add_f32_dpp v24, v20, v20 row_mirror row_mask:0xf bank_mask:0x3
    v_add_f32_dpp v25, v22, v22 row_mirror row_mask:0xf bank_mask:0x3
    s_nop 0
    v_add_f32_dpp v24, v21, v21 row_mirror row_mask:0xf bank_mask:0xc
    v_add_f32_dpp v25, v23, v23 row_mirror row_mask:0xf bank_mask:0xc
    s_nop 0
    v_add_f32_dpp v26, v24, v24 row_half_mirror row_mask:0xf bank_mask:0x5
    s_nop 1
    v_add_f32_dpp v26, v25, v25 row_half_mirror row_mask:0xf bank_mask:0xa
    s_nop 1
    v_add_f32_dpp v26, v26, v26 quad_perm:[2,3,0,1] row_mask:0xf bank_mask:0xf
    s_nop 1
    v_add_f32_dpp v26, v26, v26 quad_perm:[1,0,3,2] row_mask:0xf bank_mask:0xf
    v_cndmask_b32 v27, v27, v26, s[24:25]
    s_waitcnt vmcnt(4)
    s_xor_b32 s17, s16, s18
    s_add_u32 s16, s16, 4096
    buffer_load_dwordx4 v[80:83], v1, s[12:15], s17 offen nt
    v_dot2_f32_bf16 v20, v112, v4, 0
    v_dot2_f32_bf16 v20, v113, v5, v20
    v_dot2_f32_bf16 v20, v114, v6, v20
    v_dot2_f32_bf16 v20, v115, v7, v20
    s_waitcnt vmcnt(4)
    s_xor_b32 s17, s16, s18
    s_add_u32 s16, s16, 4096
    buffer_load_dwordx4 v[84:87], v1, s[12:15], s17 offen nt
    v_dot2_f32_bf16 v21, v116, v4, 0
    v_dot2_f32_bf16 v21, v117, v5, v21
    v_dot2_f32_bf16 v21, v118, v6, v21
    v_dot2_f32_bf16 v21, v119, v7, v21
    s_waitcnt vmcnt(4)
    s_xor_b32 s17, s16, s18
    s_add_u32 s16, s16, 4096
    buffer_load_dwordx4 v[88:91], v1, s[12:15], s17 offen nt
    v_dot2_f32_bf16 v22, v120, v4, 0
    v_dot2_f32_bf16 v22, v121, v5, v22
    v_dot2_f32_bf16 v22, v122, v6, v22
    v_dot2_f32_bf16 v22, v123, v7, v22
    s_waitcnt vmcnt(4)
    s_xor_b32 s17, s16, s18
    s_add_u32 s16, s16, 4096
    buffer_load_dwordx4 v[92:95], v1, s[12:15], s17 offen nt
    v_dot2_f32_bf16 v23, v124, v4, 0
    v_dot2_f32_bf16 v23, v125, v5, v23
    v_dot2_f32_bf16 v23, v126, v6, v23
    v_dot2_f32_bf16 v23, v127, v7, v23
    v_add_f32_dpp v24, v20, v20 row_mirror row_mask:0xf bank_mask:0x3
    v_add_f32_dpp v25, v22, v22 row_mirror row_mask:0xf bank_mask:0x3
    s_nop 0
    v_add_f32_dpp v24, v21, v21 row_mirror row_mask:0xf bank_mask:0xc
    v_add_f32_dpp v25, v23, v23 row_mirror row_mask:0xf bank_mask:0xc
    s_nop 0
    v_add_f32_dpp v26, v24, v24 row_half_mirror row_mask:0xf bank_mask:0x5
    s_nop 1
    v_add_f32_dpp v26, v25, v25 row_half_mirror row_mask:0xf bank_mask:0xa
    s_nop 1
    v_add_f32_dpp v26, v26, v26 quad_perm:[2,3,0,1] row_mask:0xf bank_mask:0xf
    s_nop 1
    v_add_f32_dpp v26, v26, v26 quad_perm:[1,0,3,2] row_mask:0xf bank_mask:0xf
    v_cndmask_b32 v27, v27, v26, s[26:27]
    v_cvt_pk_bf16_f32 v27, 0, v27
    v_mul_f32 v27, 0x3db504f3, v27
    v_cvt_pk_bf16_f32 v63, 0, v27
    v_max_f32 v29, v29, v63
    s_nop 1
    v_max_f32_dpp v29, v29, v29 row_ror:8 row_mask:0xf bank_mask:0xf
    s_nop 1
    v_max_f32_dpp v29, v29, v29 row_ror:4 row_mask:0xf bank_mask:0xf
    s_nop 1
    v_max_f32_dpp v29, v29, v29 row_ror:2 row_mask:0xf bank_mask:0xf
    s_nop 1
    v_max_f32_dpp v29, v29, v29 row_ror:1 row_mask:0xf bank_mask:0xf
    s_nop 1
    v_max_f32_dpp v29, v29, v29 row_bcast:15 row_mask:0xa bank_mask:0xf
    s_nop 1
    v_max_f32_dpp v29, v29, v29 row_bcast:31 row_mask:0xc bank_mask:0xf
    s_nop 0
    v_readlane_b32 s21, v29, 63
    v_mov_b32 v12, 0
    v_mov_b32 v13, 0
    v_mov_b32 v14, 0
    v_mov_b32 v15, 0
    v_mov_b32 v29, 0xbfb8aa3b
    v_mul_f32 v29, s21, v29
    v_fma_f32 v32, v32, s20, v29
    v_fma_f32 v33, v33, s20, v29
    v_fma_f32 v34, v34, s20, v29
    v_fma_f32 v35, v35, s20, v29
    v_fma_f32 v36, v36, s20, v29
    v_fma_f32 v37, v37, s20, v29
    v_fma_f32 v38, v38, s20, v29
    v_fma_f32 v39, v39, s20, v29
    v_exp_f32 v32, v32
    v_exp_f32 v33, v33
    v_exp_f32 v34, v34
    v_exp_f32 v35, v35
    v_exp_f32 v36, v36
    v_exp_f32 v37, v37
    v_exp_f32 v38, v38
    v_exp_f32 v39, v39
    v_mov_b32 v28, v32
    v_mov_b32 v2, v33
    v_add_f32 v28, v28, v34
    v_add_f32 v2, v2, v35
    v_add_f32 v28, v28, v36
    v_add_f32 v2, v2, v37
    v_add_f32 v28, v28, v38
    v_add_f32 v2, v2, v39
    v_cvt_pk_bf16_f32 v32, v32, v32
    v_cvt_pk_bf16_f32 v33, v33, v33
    v_cvt_pk_bf16_f32 v34, v34, v34
    v_cvt_pk_bf16_f32 v35, v35, v35
    v_cvt_pk_bf16_f32 v36, v36, v36
    v_cvt_pk_bf16_f32 v37, v37, v37
    v_cvt_pk_bf16_f32 v38, v38, v38
    v_cvt_pk_bf16_f32 v39, v39, v39
    s_waitcnt vmcnt(4)
    s_xor_b32 s17, s16, s18
    s_add_u32 s16, s16, 4096
    buffer_load_dwordx4 v[96:99], v1, s[12:15], s17 offen nt
    v_fma_f32 v40, v40, s20, v29
    v_fma_f32 v41, v41, s20, v29
    v_fma_f32 v42, v42, s20, v29
    v_fma_f32 v43, v43, s20, v29
    v_fma_f32 v44, v44, s20, v29
    v_fma_f32 v45, v45, s20, v29
    v_fma_f32 v46, v46, s20, v29
    v_fma_f32 v47, v47, s20, v29
    v_exp_f32 v40, v40
    v_exp_f32 v41, v41
    v_exp_f32 v42, v42
    v_exp_f32 v43, v43
    v_exp_f32 v44, v44
    v_exp_f32 v45, v45
    v_exp_f32 v46, v46
    v_exp_f32 v47, v47
    v_add_f32 v28, v28, v40
    v_add_f32 v2, v2, v41
    v_add_f32 v28, v28, v42
    v_add_f32 v2, v2, v43
    v_add_f32 v28, v28, v44
    v_add_f32 v2, v2, v45
    v_add_f32 v28, v28, v46
    v_add_f32 v2, v2, v47
    v_cvt_pk_bf16_f32 v40, v40, v40
    v_cvt_pk_bf16_f32 v41, v41, v41
    v_cvt_pk_bf16_f32 v42, v42, v42
    v_cvt_pk_bf16_f32 v43, v43, v43
    v_cvt_pk_bf16_f32 v44, v44, v44
    v_cvt_pk_bf16_f32 v45, v45, v45
    v_cvt_pk_bf16_f32 v46, v46, v46
    v_cvt_pk_bf16_f32 v47, v47, v47
    v_fma_f32 v48, v48, s20, v29
    v_fma_f32 v49, v49, s20, v29
    v_fma_f32 v50, v50, s20, v29
    v_fma_f32 v51, v51, s20, v29
    v_fma_f32 v52, v52, s20, v29
    v_fma_f32 v53, v53, s20, v29
    v_fma_f32 v54, v54, s20, v29
    v_fma_f32 v55, v55, s20, v29
    v_exp_f32 v48, v48
    v_exp_f32 v49, v49
    v_exp_f32 v50, v50
    v_exp_f32 v51, v51
    v_exp_f32 v52, v52
    v_exp_f32 v53, v53
    v_exp_f32 v54, v54
    v_exp_f32 v55, v55
    v_add_f32 v28, v28, v48
    v_add_f32 v2, v2, v49
    v_add_f32 v28, v28, v50
    v_add_f32 v2, v2, v51
    v_add_f32 v28, v28, v52
    v_add_f32 v2, v2, v53
    v_add_f32 v28, v28, v54
    v_add_f32 v2, v2, v55
    v_cvt_pk_bf16_f32 v48, v48, v48
    v_cvt_pk_bf16_f32 v49, v49, v49
    v_cvt_pk_bf16_f32 v50, v50, v50
    v_cvt_pk_bf16_f32 v51, v51, v51
    v_cvt_pk_bf16_f32 v52, v52, v52
    v_cvt_pk_bf16_f32 v53, v53, v53
    v_cvt_pk_bf16_f32 v54, v54, v54
    v_cvt_pk_bf16_f32 v55, v55, v55
    s_waitcnt vmcnt(4)
    s_xor_b32 s17, s16, s18
    s_add_u32 s16, s16, 4096
    buffer_load_dwordx4 v[100:103], v1, s[12:15], s17 offen nt
    v_fma_f32 v56, v56, s20, v29
    v_fma_f32 v57, v57, s20, v29
    v_fma_f32 v58, v58, s20, v29
    v_fma_f32 v59, v59, s20, v29
    v_fma_f32 v60, v60, s20, v29
    v_fma_f32 v61, v61, s20, v29
    v_fma_f32 v62, v62, s20, v29
    v_fma_f32 v63, v63, s20, v29
    v_exp_f32 v56, v56
    v_exp_f32 v57, v57
    v_exp_f32 v58, v58
    v_exp_f32 v59, v59
    v_exp_f32 v60, v60
    v_exp_f32 v61, v61
    v_exp_f32 v62, v62
    v_exp_f32 v63, v63
    v_add_f32 v28, v28, v56
    v_add_f32 v2, v2, v57
    v_add_f32 v28, v28, v58
    v_add_f32 v2, v2, v59
    v_add_f32 v28, v28, v60
    v_add_f32 v2, v2, v61
    v_add_f32 v28, v28, v62
    v_add_f32 v2, v2, v63
    v_cvt_pk_bf16_f32 v56, v56, v56
    v_cvt_pk_bf16_f32 v57, v57, v57
    v_cvt_pk_bf16_f32 v58, v58, v58
    v_cvt_pk_bf16_f32 v59, v59, v59
    v_cvt_pk_bf16_f32 v60, v60, v60
    v_cvt_pk_bf16_f32 v61, v61, v61
    v_cvt_pk_bf16_f32 v62, v62, v62
    v_cvt_pk_bf16_f32 v63, v63, v63
    v_add_f32 v28, v28, v2
    s_nop 1
    v_add_f32_dpp v28, v28, v28 row_ror:8 row_mask:0xf bank_mask:0xf
    s_nop 1
    v_add_f32_dpp v28, v28, v28 row_ror:4 row_mask:0xf bank_mask:0xf
    s_nop 1
    v_add_f32_dpp v28, v28, v28 row_ror:2 row_mask:0xf bank_mask:0xf
    s_nop 1
    v_add_f32_dpp v28, v28, v28 row_ror:1 row_mask:0xf bank_mask:0xf
    s_nop 1
    v_add_f32_dpp v28, v28, v28 row_bcast:15 row_mask:0xa bank_mask:0xf
    s_lshl_b32 s21, s3, 3
    v_mov_b32 v3, s21
    v_add_f32_dpp v28, v28, v28 row_bcast:31 row_mask:0xc bank_mask:0xf
    s_mov_b32 exec_lo, 0
    s_mov_b32 exec_hi, 0x80000000
    ds_write_b64 v3, v[28:29] offset:6144
    v_mov_b32 v2, 0
    v_mov_b32 v3, 1
    ds_add_u32 v2, v3 offset:6276
    s_mov_b64 exec, -1
    v_and_b32_dpp v16, v32, v8 row_newbcast:0 row_mask:0xf bank_mask:0xf
    v_and_b32_dpp v17, v32, v9 row_newbcast:0 row_mask:0xf bank_mask:0xf
    v_and_b32_dpp v18, v32, v10 row_newbcast:0 row_mask:0xf bank_mask:0xf
    v_and_b32_dpp v19, v32, v11 row_newbcast:0 row_mask:0xf bank_mask:0xf
    s_nop 1
    v_mfma_f32_16x16x32_bf16 v[12:15], v[16:19], v[64:67], v[12:15]
    v_and_b32_dpp v16, v32, v8 row_newbcast:8 row_mask:0xf bank_mask:0xf
    v_and_b32_dpp v17, v32, v9 row_newbcast:8 row_mask:0xf bank_mask:0xf
    v_and_b32_dpp v18, v32, v10 row_newbcast:8 row_mask:0xf bank_mask:0xf
    v_and_b32_dpp v19, v32, v11 row_newbcast:8 row_mask:0xf bank_mask:0xf
    s_nop 1
    v_mfma_f32_16x16x32_bf16 v[12:15], v[16:19], v[68:71], v[12:15]
    s_waitcnt vmcnt(4)
    s_xor_b32 s17, s16, s18
    s_add_u32 s16, s16, 4096
    buffer_load_dwordx4 v[104:107], v1, s[12:15], s17 offen nt
    v_and_b32_dpp v16, v32, v8 row_newbcast:4 row_mask:0xf bank_mask:0xf
    v_and_b32_dpp v17, v32, v9 row_newbcast:4 row_mask:0xf bank_mask:0xf
    v_and_b32_dpp v18, v32, v10 row_newbcast:4 row_mask:0xf bank_mask:0xf
    v_and_b32_dpp v19, v32, v11 row_newbcast:4 row_mask:0xf bank_mask:0xf
    s_nop 1
    v_mfma_f32_16x16x32_bf16 v[12:15], v[16:19], v[72:75], v[12:15]
    s_waitcnt vmcnt(4)
    s_xor_b32 s17, s16, s18
    s_add_u32 s16, s16, 4096
    buffer_load_dwordx4 v[108:111], v1, s[12:15], s17 offen nt
    v_and_b32_dpp v16, v32, v8 row_newbcast:12 row_mask:0xf bank_mask:0xf
    v_and_b32_dpp v17, v32, v9 row_newbcast:12 row_mask:0xf bank_mask:0xf
    v_and_b32_dpp v18, v32, v10 row_newbcast:12 row_mask:0xf bank_mask:0xf
    v_and_b32_dpp v19, v32, v11 row_newbcast:12 row_mask:0xf bank_mask:0xf
    s_nop 1
    v_mfma_f32_16x16x32_bf16 v[12:15], v[16:19], v[76:79], v[12:15]
    s_waitcnt vmcnt(4)
    s_xor_b32 s17, s16, s18
    s_add_u32 s16, s16, 4096
    buffer_load_dwordx4 v[112:115], v1, s[12:15], s17 offen nt
    v_and_b32_dpp v16, v32, v8 row_newbcast:1 row_mask:0xf bank_mask:0xf
    v_and_b32_dpp v17, v32, v9 row_newbcast:1 row_mask:0xf bank_mask:0xf
    v_and_b32_dpp v18, v32, v10 row_newbcast:1 row_mask:0xf bank_mask:0xf
    v_and_b32_dpp v19, v32, v11 row_newbcast:1 row_mask:0xf bank_mask:0xf
    s_nop 1
    v_mfma_f32_16x16x32_bf16 v[12:15], v[16:19], v[80:83], v[12:15]
    s_waitcnt vmcnt(4)
    s_xor_b32 s17, s16, s18
    s_add_u32 s16, s16, 4096
    buffer_load_dwordx4 v[116:119], v1, s[12:15], s17 offen nt
    v_and_b32_dpp v16, v32, v8 row_newbcast:9 row_mask:0xf bank_mask:0xf
    v_and_b32_dpp v17, v32, v9 row_newbcast:9 row_mask:0xf bank_mask:0xf
    v_and_b32_dpp v18, v32, v10 row_newbcast:9 row_mask:0xf bank_mask:0xf
    v_and_b32_dpp v19, v32, v11 row_newbcast:9 row_mask:0xf bank_mask:0xf
    s_nop 1
    v_mfma_f32_16x16x32_bf16 v[12:15], v[16:19], v[84:87], v[12:15]
    s_waitcnt vmcnt(4)
    s_xor_b32 s17, s16, s18
    s_add_u32 s16, s16, 4096
    buffer_load_dwordx4 v[120:123], v1, s[12:15], s17 offen nt
    v_and_b32_dpp v16, v32, v8 row_newbcast:5 row_mask:0xf bank_mask:0xf
    v_and_b32_dpp v17, v32, v9 row_newbcast:5 row_mask:0xf bank_mask:0xf
    v_and_b32_dpp v18, v32, v10 row_newbcast:5 row_mask:0xf bank_mask:0xf
    v_and_b32_dpp v19, v32, v11 row_newbcast:5 row_mask:0xf bank_mask:0xf
    s_nop 1
    v_mfma_f32_16x16x32_bf16 v[12:15], v[16:19], v[88:91], v[12:15]
    s_waitcnt vmcnt(4)
    s_xor_b32 s17, s16, s18
    s_add_u32 s16, s16, 4096
    buffer_load_dwordx4 v[124:127], v1, s[12:15], s17 offen nt
    v_and_b32_dpp v16, v32, v8 row_newbcast:13 row_mask:0xf bank_mask:0xf
    v_and_b32_dpp v17, v32, v9 row_newbcast:13 row_mask:0xf bank_mask:0xf
    v_and_b32_dpp v18, v32, v10 row_newbcast:13 row_mask:0xf bank_mask:0xf
    v_and_b32_dpp v19, v32, v11 row_newbcast:13 row_mask:0xf bank_mask:0xf
    s_nop 1
    v_mfma_f32_16x16x32_bf16 v[12:15], v[16:19], v[92:95], v[12:15]
    s_waitcnt vmcnt(4)
    s_and_b32 s16, s16, 0x1fffff
    s_lshl_b32 s34, s16, 3
    s_and_b32 s34, s34, 0xe00000
    s_xor_b32 s34, s34, s35
    s_or_b32 s16, s16, s34
    s_xor_b32 s17, s16, s18
    s_add_u32 s16, s16, 4096
    buffer_load_dwordx4 v[64:67], v1, s[12:15], s17 offen nt
    v_and_b32_dpp v16, v32, v8 row_newbcast:2 row_mask:0xf bank_mask:0xf
    v_and_b32_dpp v17, v32, v9 row_newbcast:2 row_mask:0xf bank_mask:0xf
    v_and_b32_dpp v18, v32, v10 row_newbcast:2 row_mask:0xf bank_mask:0xf
    v_and_b32_dpp v19, v32, v11 row_newbcast:2 row_mask:0xf bank_mask:0xf
    s_nop 1
    v_mfma_f32_16x16x32_bf16 v[12:15], v[16:19], v[96:99], v[12:15]
    s_waitcnt vmcnt(4)
    s_xor_b32 s17, s16, s18
    s_add_u32 s16, s16, 4096
    buffer_load_dwordx4 v[68:71], v1, s[12:15], s17 offen nt
    v_and_b32_dpp v16, v32, v8 row_newbcast:10 row_mask:0xf bank_mask:0xf
    v_and_b32_dpp v17, v32, v9 row_newbcast:10 row_mask:0xf bank_mask:0xf
    v_and_b32_dpp v18, v32, v10 row_newbcast:10 row_mask:0xf bank_mask:0xf
    v_and_b32_dpp v19, v32, v11 row_newbcast:10 row_mask:0xf bank_mask:0xf
    s_nop 1
    v_mfma_f32_16x16x32_bf16 v[12:15], v[16:19], v[100:103], v[12:15]
    s_waitcnt vmcnt(4)
    s_xor_b32 s17, s16, s18
    s_add_u32 s16, s16, 4096
    buffer_load_dwordx4 v[72:75], v1, s[12:15], s17 offen nt
    v_and_b32_dpp v16, v32, v8 row_newbcast:6 row_mask:0xf bank_mask:0xf
    v_and_b32_dpp v17, v32, v9 row_newbcast:6 row_mask:0xf bank_mask:0xf
    v_and_b32_dpp v18, v32, v10 row_newbcast:6 row_mask:0xf bank_mask:0xf
    v_and_b32_dpp v19, v32, v11 row_newbcast:6 row_mask:0xf bank_mask:0xf
    s_nop 1
    v_mfma_f32_16x16x32_bf16 v[12:15], v[16:19], v[104:107], v[12:15]
    s_waitcnt vmcnt(4)
    s_xor_b32 s17, s16, s18
    s_add_u32 s16, s16, 4096
    buffer_load_dwordx4 v[76:79], v1, s[12:15], s17 offen nt
    v_and_b32_dpp v16, v32, v8 row_newbcast:14 row_mask:0xf bank_mask:0xf
    v_and_b32_dpp v17, v32, v9 row_newbcast:14 row_mask:0xf bank_mask:0xf
    v_and_b32_dpp v18, v32, v10 row_newbcast:14 row_mask:0xf bank_mask:0xf
    v_and_b32_dpp v19, v32, v11 row_newbcast:14 row_mask:0xf bank_mask:0xf
    s_nop 1
    v_mfma_f32_16x16x32_bf16 v[12:15], v[16:19], v[108:111], v[12:15]
    s_waitcnt vmcnt(4)
    s_xor_b32 s17, s16, s18
    s_add_u32 s16, s16, 4096
    buffer_load_dwordx4 v[80:83], v1, s[12:15], s17 offen nt
    v_and_b32_dpp v16, v32, v8 row_newbcast:3 row_mask:0xf bank_mask:0xf
    v_and_b32_dpp v17, v32, v9 row_newbcast:3 row_mask:0xf bank_mask:0xf
    v_and_b32_dpp v18, v32, v10 row_newbcast:3 row_mask:0xf bank_mask:0xf
    v_and_b32_dpp v19, v32, v11 row_newbcast:3 row_mask:0xf bank_mask:0xf
    s_nop 1
    v_mfma_f32_16x16x32_bf16 v[12:15], v[16:19], v[112:115], v[12:15]
    s_waitcnt vmcnt(4)
    s_xor_b32 s17, s16, s18
    s_add_u32 s16, s16, 4096
    buffer_load_dwordx4 v[84:87], v1, s[12:15], s17 offen nt
    v_and_b32_dpp v16, v32, v8 row_newbcast:11 row_mask:0xf bank_mask:0xf
    v_and_b32_dpp v17, v32, v9 row_newbcast:11 row_mask:0xf bank_mask:0xf
    v_and_b32_dpp v18, v32, v10 row_newbcast:11 row_mask:0xf bank_mask:0xf
    v_and_b32_dpp v19, v32, v11 row_newbcast:11 row_mask:0xf bank_mask:0xf
    s_nop 1
    v_mfma_f32_16x16x32_bf16 v[12:15], v[16:19], v[116:119], v[12:15]
    s_waitcnt vmcnt(4)
    s_xor_b32 s17, s16, s18
    s_add_u32 s16, s16, 4096
    buffer_load_dwordx4 v[88:91], v1, s[12:15], s17 offen nt
    v_and_b32_dpp v16, v32, v8 row_newbcast:7 row_mask:0xf bank_mask:0xf
    v_and_b32_dpp v17, v32, v9 row_newbcast:7 row_mask:0xf bank_mask:0xf
    v_and_b32_dpp v18, v32, v10 row_newbcast:7 row_mask:0xf bank_mask:0xf
    v_and_b32_dpp v19, v32, v11 row_newbcast:7 row_mask:0xf bank_mask:0xf
    s_nop 1
    v_mfma_f32_16x16x32_bf16 v[12:15], v[16:19], v[120:123], v[12:15]
    s_waitcnt vmcnt(4)
    s_xor_b32 s17, s16, s18
    s_add_u32 s16, s16, 4096
    buffer_load_dwordx4 v[92:95], v1, s[12:15], s17 offen nt
    v_and_b32_dpp v16, v32, v8 row_newbcast:15 row_mask:0xf bank_mask:0xf
    v_and_b32_dpp v17, v32, v9 row_newbcast:15 row_mask:0xf bank_mask:0xf
    v_and_b32_dpp v18, v32, v10 row_newbcast:15 row_mask:0xf bank_mask:0xf
    v_and_b32_dpp v19, v32, v11 row_newbcast:15 row_mask:0xf bank_mask:0xf
    s_nop 1
    v_mfma_f32_16x16x32_bf16 v[12:15], v[16:19], v[124:127], v[12:15]
    v_mov_b32 v2, 0
    ds_read_b32 v2, v2 offset:6284
    s_mov_b32 s19, 1
    s_waitcnt lgkmcnt(0)
    v_readfirstlane_b32 s46, v2
    s_nop 0
    s_and_b32 s47, s46, 31
    s_cbranch_scc0 L_vloop
    s_add_u32 s47, s47, 1
    s_bitcmp1_b32 s46, 7
    s_cbranch_scc1 L_vnarrow
L_vwider:
    s_waitcnt vmcnt(5)
    s_xor_b32 s17, s16, s18
    s_add_u32 s16, s16, 4096
    buffer_load_dwordx4 v[96:99], v1, s[12:15], s17 offen nt
    s_set_gpr_idx_on s19, gpr_idx(SRC0)
    s_nop 0
    v_mov_b32 v30, v32
    s_set_gpr_idx_off
    s_nop 0
    v_and_b32_dpp v16, v30, v8 row_newbcast:0 row_mask:0xf bank_mask:0xf
    v_and_b32_dpp v17, v30, v9 row_newbcast:0 row_mask:0xf bank_mask:0xf
    v_and_b32_dpp v18, v30, v10 row_newbcast:0 row_mask:0xf bank_mask:0xf
    v_and_b32_dpp v19, v30, v11 row_newbcast:0 row_mask:0xf bank_mask:0xf
    s_nop 1
    v_mfma_f32_16x16x32_bf16 v[12:15], v[16:19], v[64:67], v[12:15]
    s_waitcnt vmcnt(5)
    s_xor_b32 s17, s16, s18
    s_add_u32 s16, s16, 4096
    buffer_load_dwordx4 v[100:103], v1, s[12:15], s17 offen nt
    v_and_b32_dpp v16, v30, v8 row_newbcast:8 row_mask:0xf bank_mask:0xf
    v_and_b32_dpp v17, v30, v9 row_newbcast:8 row_mask:0xf bank_mask:0xf
    v_and_b32_dpp v18, v30, v10 row_newbcast:8 row_mask:0xf bank_mask:0xf
    v_and_b32_dpp v19, v30, v11 row_newbcast:8 row_mask:0xf bank_mask:0xf
    s_nop 1
    v_mfma_f32_16x16x32_bf16 v[12:15], v[16:19], v[68:71], v[12:15]
    s_waitcnt vmcnt(5)
    s_xor_b32 s17, s16, s18
    s_add_u32 s16, s16, 4096
    buffer_load_dwordx4 v[104:107], v1, s[12:15], s17 offen nt
    v_and_b32_dpp v16, v30, v8 row_newbcast:4 row_mask:0xf bank_mask:0xf
    v_and_b32_dpp v17, v30, v9 row_newbcast:4 row_mask:0xf bank_mask:0xf
    v_and_b32_dpp v18, v30, v10 row_newbcast:4 row_mask:0xf bank_mask:0xf
    v_and_b32_dpp v19, v30, v11 row_newbcast:4 row_mask:0xf bank_mask:0xf
    s_nop 1
    v_mfma_f32_16x16x32_bf16 v[12:15], v[16:19], v[72:75], v[12:15]
    s_waitcnt vmcnt(5)
    s_xor_b32 s17, s16, s18
    s_add_u32 s16, s16, 4096
    buffer_load_dwordx4 v[108:111], v1, s[12:15], s17 offen nt
    v_and_b32_dpp v16, v30, v8 row_newbcast:12 row_mask:0xf bank_mask:0xf
    v_and_b32_dpp v17, v30, v9 row_newbcast:12 row_mask:0xf bank_mask:0xf
    v_and_b32_dpp v18, v30, v10 row_newbcast:12 row_mask:0xf bank_mask:0xf
    v_and_b32_dpp v19, v30, v11 row_newbcast:12 row_mask:0xf bank_mask:0xf
    s_nop 1
    v_mfma_f32_16x16x32_bf16 v[12:15], v[16:19], v[76:79], v[12:15]
    s_waitcnt vmcnt(5)
    s_xor_b32 s17, s16, s18
    s_add_u32 s16, s16, 4096
    buffer_load_dwordx4 v[112:115], v1, s[12:15], s17 offen nt
    v_and_b32_dpp v16, v30, v8 row_newbcast:1 row_mask:0xf bank_mask:0xf
    v_and_b32_dpp v17, v30, v9 row_newbcast:1 row_mask:0xf bank_mask:0xf
    v_and_b32_dpp v18, v30, v10 row_newbcast:1 row_mask:0xf bank_mask:0xf
    v_and_b32_dpp v19, v30, v11 row_newbcast:1 row_mask:0xf bank_mask:0xf
    s_nop 1
    v_mfma_f32_16x16x32_bf16 v[12:15], v[16:19], v[80:83], v[12:15]
    s_waitcnt vmcnt(5)
    s_xor_b32 s17, s16, s18
    s_add_u32 s16, s16, 4096
    buffer_load_dwordx4 v[116:119], v1, s[12:15], s17 offen nt
    v_and_b32_dpp v16, v30, v8 row_newbcast:9 row_mask:0xf bank_mask:0xf
    v_and_b32_dpp v17, v30, v9 row_newbcast:9 row_mask:0xf bank_mask:0xf
    v_and_b32_dpp v18, v30, v10 row_newbcast:9 row_mask:0xf bank_mask:0xf
    v_and_b32_dpp v19, v30, v11 row_newbcast:9 row_mask:0xf bank_mask:0xf
    s_nop 1
    v_mfma_f32_16x16x32_bf16 v[12:15], v[16:19], v[84:87], v[12:15]
    s_waitcnt vmcnt(5)
    s_xor_b32 s17, s16, s18
    s_add_u32 s16, s16, 4096
    buffer_load_dwordx4 v[120:123], v1, s[12:15], s17 offen nt
    v_and_b32_dpp v16, v30, v8 row_newbcast:5 row_mask:0xf bank_mask:0xf
    v_and_b32_dpp v17, v30, v9 row_newbcast:5 row_mask:0xf bank_mask:0xf
    v_and_b32_dpp v18, v30, v10 row_newbcast:5 row_mask:0xf bank_mask:0xf
    v_and_b32_dpp v19, v30, v11 row_newbcast:5 row_mask:0xf bank_mask:0xf
    s_nop 1
    v_mfma_f32_16x16x32_bf16 v[12:15], v[16:19], v[88:91], v[12:15]
    s_waitcnt vmcnt(5)
    s_xor_b32 s17, s16, s18
    s_add_u32 s16, s16, 4096
    buffer_load_dwordx4 v[124:127], v1, s[12:15], s17 offen nt
    v_and_b32_dpp v16, v30, v8 row_newbcast:13 row_mask:0xf bank_mask:0xf
    v_and_b32_dpp v17, v30, v9 row_newbcast:13 row_mask:0xf bank_mask:0xf
    v_and_b32_dpp v18, v30, v10 row_newbcast:13 row_mask:0xf bank_mask:0xf
    v_and_b32_dpp v19, v30, v11 row_newbcast:13 row_mask:0xf bank_mask:0xf
    s_nop 1
    v_mfma_f32_16x16x32_bf16 v[12:15], v[16:19], v[92:95], v[12:15]
    s_waitcnt vmcnt(5)
    s_and_b32 s16, s16, 0x1fffff
    s_lshl_b32 s34, s16, 3
    s_and_b32 s34, s34, 0xe00000
    s_xor_b32 s34, s34, s35
    s_or_b32 s16, s16, s34
    s_xor_b32 s17, s16, s18
    s_add_u32 s16, s16, 4096
    buffer_load_dwordx4 v[64:67], v1, s[12:15], s17 offen nt
    v_and_b32_dpp v16, v30, v8 row_newbcast:2 row_mask:0xf bank_mask:0xf
    v_and_b32_dpp v17, v30, v9 row_newbcast:2 row_mask:0xf bank_mask:0xf
    v_and_b32_dpp v18, v30, v10 row_newbcast:2 row_mask:0xf bank_mask:0xf
    v_and_b32_dpp v19, v30, v11 row_newbcast:2 row_mask:0xf bank_mask:0xf
    s_nop 1
    v_mfma_f32_16x16x32_bf16 v[12:15], v[16:19], v[96:99], v[12:15]
    s_waitcnt vmcnt(5)
    s_xor_b32 s17, s16, s18
    s_add_u32 s16, s16, 4096
    buffer_load_dwordx4 v[68:71], v1, s[12:15], s17 offen nt
    v_and_b32_dpp v16, v30, v8 row_newbcast:10 row_mask:0xf bank_mask:0xf
    v_and_b32_dpp v17, v30, v9 row_newbcast:10 row_mask:0xf bank_mask:0xf
    v_and_b32_dpp v18, v30, v10 row_newbcast:10 row_mask:0xf bank_mask:0xf
    v_and_b32_dpp v19, v30, v11 row_newbcast:10 row_mask:0xf bank_mask:0xf
    s_nop 1
    v_mfma_f32_16x16x32_bf16 v[12:15], v[16:19], v[100:103], v[12:15]
    s_waitcnt vmcnt(5)
    s_xor_b32 s17, s16, s18
    s_add_u32 s16, s16, 4096
    buffer_load_dwordx4 v[72:75], v1, s[12:15], s17 offen nt
    v_and_b32_dpp v16, v30, v8 row_newbcast:6 row_mask:0xf bank_mask:0xf
    v_and_b32_dpp v17, v30, v9 row_newbcast:6 row_mask:0xf bank_mask:0xf
    v_and_b32_dpp v18, v30, v10 row_newbcast:6 row_mask:0xf bank_mask:0xf
    v_and_b32_dpp v19, v30, v11 row_newbcast:6 row_mask:0xf bank_mask:0xf
    s_nop 1
    v_mfma_f32_16x16x32_bf16 v[12:15], v[16:19], v[104:107], v[12:15]
    s_waitcnt vmcnt(5)
    s_xor_b32 s17, s16, s18
    s_add_u32 s16, s16, 4096
    buffer_load_dwordx4 v[76:79], v1, s[12:15], s17 offen nt
    v_and_b32_dpp v16, v30, v8 row_newbcast:14 row_mask:0xf bank_mask:0xf
    v_and_b32_dpp v17, v30, v9 row_newbcast:14 row_mask:0xf bank_mask:0xf
    v_and_b32_dpp v18, v30, v10 row_newbcast:14 row_mask:0xf bank_mask:0xf
    v_and_b32_dpp v19, v30, v11 row_newbcast:14 row_mask:0xf bank_mask:0xf
    s_nop 1
    v_mfma_f32_16x16x32_bf16 v[12:15], v[16:19], v[108:111], v[12:15]
    s_waitcnt vmcnt(5)
    s_xor_b32 s17, s16, s18
    s_add_u32 s16, s16, 4096
    buffer_load_dwordx4 v[80:83], v1, s[12:15], s17 offen nt
    v_and_b32_dpp v16, v30, v8 row_newbcast:3 row_mask:0xf bank_mask:0xf
    v_and_b32_dpp v17, v30, v9 row_newbcast:3 row_mask:0xf bank_mask:0xf
    v_and_b32_dpp v18, v30, v10 row_newbcast:3 row_mask:0xf bank_mask:0xf
    v_and_b32_dpp v19, v30, v11 row_newbcast:3 row_mask:0xf bank_mask:0xf
    s_nop 1
    v_mfma_f32_16x16x32_bf16 v[12:15], v[16:19], v[112:115], v[12:15]
    s_waitcnt vmcnt(5)
    s_xor_b32 s17, s16, s18
    s_add_u32 s16, s16, 4096
    buffer_load_dwordx4 v[84:87], v1, s[12:15], s17 offen nt
    v_and_b32_dpp v16, v30, v8 row_newbcast:11 row_mask:0xf bank_mask:0xf
    v_and_b32_dpp v17, v30, v9 row_newbcast:11 row_mask:0xf bank_mask:0xf
    v_and_b32_dpp v18, v30, v10 row_newbcast:11 row_mask:0xf bank_mask:0xf
    v_and_b32_dpp v19, v30, v11 row_newbcast:11 row_mask:0xf bank_mask:0xf
    s_nop 1
    v_mfma_f32_16x16x32_bf16 v[12:15], v[16:19], v[116:119], v[12:15]
    s_waitcnt vmcnt(5)
    s_xor_b32 s17, s16, s18
    s_add_u32 s16, s16, 4096
    buffer_load_dwordx4 v[88:91], v1, s[12:15], s17 offen nt
    v_and_b32_dpp v16, v30, v8 row_newbcast:7 row_mask:0xf bank_mask:0xf
    v_and_b32_dpp v17, v30, v9 row_newbcast:7 row_mask:0xf bank_mask:0xf
    v_and_b32_dpp v18, v30, v10 row_newbcast:7 row_mask:0xf bank_mask:0xf
    v_and_b32_dpp v19, v30, v11 row_newbcast:7 row_mask:0xf bank_mask:0xf
    s_nop 1
    v_mfma_f32_16x16x32_bf16 v[12:15], v[16:19], v[120:123], v[12:15]
    s_waitcnt vmcnt(5)
    s_xor_b32 s17, s16, s18
    s_add_u32 s16, s16, 4096
    buffer_load_dwordx4 v[92:95], v1, s[12:15], s17 offen nt
    v_and_b32_dpp v16, v30, v8 row_newbcast:15 row_mask:0xf bank_mask:0xf
    v_and_b32_dpp v17, v30, v9 row_newbcast:15 row_mask:0xf bank_mask:0xf
    v_and_b32_dpp v18, v30, v10 row_newbcast:15 row_mask:0xf bank_mask:0xf
    v_and_b32_dpp v19, v30, v11 row_newbcast:15 row_mask:0xf bank_mask:0xf
    s_nop 1
    v_mfma_f32_16x16x32_bf16 v[12:15], v[16:19], v[124:127], v[12:15]
    s_add_u32 s19, s19, 1
    s_cmp_lg_u32 s19, s47
    s_cbranch_scc1 L_vwider
    s_branch L_vloop
L_vnarrow:
    s_waitcnt vmcnt(3)
    s_xor_b32 s17, s16, s18
    s_add_u32 s16, s16, 4096
    buffer_load_dwordx4 v[96:99], v1, s[12:15], s17 offen nt
    s_set_gpr_idx_on s19, gpr_idx(SRC0)
    s_nop 0
    v_mov_b32 v30, v32
    s_set_gpr_idx_off
    s_nop 0
    v_and_b32_dpp v16, v30, v8 row_newbcast:0 row_mask:0xf bank_mask:0xf
    v_and_b32_dpp v17, v30, v9 row_newbcast:0 row_mask:0xf bank_mask:0xf
    v_and_b32_dpp v18, v30, v10 row_newbcast:0 row_mask:0xf bank_mask:0xf
    v_and_b32_dpp v19, v30, v11 row_newbcast:0 row_mask:0xf bank_mask:0xf
    s_nop 1
    v_mfma_f32_16x16x32_bf16 v[12:15], v[16:19], v[64:67], v[12:15]
    s_waitcnt vmcnt(3)
    s_xor_b32 s17, s16, s18
    s_add_u32 s16, s16, 4096
    buffer_load_dwordx4 v[100:103], v1, s[12:15], s17 offen nt
    v_and_b32_dpp v16, v30, v8 row_newbcast:8 row_mask:0xf bank_mask:0xf
    v_and_b32_dpp v17, v30, v9 row_newbcast:8 row_mask:0xf bank_mask:0xf
    v_and_b32_dpp v18, v30, v10 row_newbcast:8 row_mask:0xf bank_mask:0xf
    v_and_b32_dpp v19, v30, v11 row_newbcast:8 row_mask:0xf bank_mask:0xf
    s_nop 1
    v_mfma_f32_16x16x32_bf16 v[12:15], v[16:19], v[68:71], v[12:15]
    s_waitcnt vmcnt(3)
    s_xor_b32 s17, s16, s18
    s_add_u32 s16, s16, 4096
    buffer_load_dwordx4 v[104:107], v1, s[12:15], s17 offen nt
    v_and_b32_dpp v16, v30, v8 row_newbcast:4 row_mask:0xf bank_mask:0xf
    v_and_b32_dpp v17, v30, v9 row_newbcast:4 row_mask:0xf bank_mask:0xf
    v_and_b32_dpp v18, v30, v10 row_newbcast:4 row_mask:0xf bank_mask:0xf
    v_and_b32_dpp v19, v30, v11 row_newbcast:4 row_mask:0xf bank_mask:0xf
    s_nop 1
    v_mfma_f32_16x16x32_bf16 v[12:15], v[16:19], v[72:75], v[12:15]
    s_waitcnt vmcnt(3)
    s_xor_b32 s17, s16, s18
    s_add_u32 s16, s16, 4096
    buffer_load_dwordx4 v[108:111], v1, s[12:15], s17 offen nt
    v_and_b32_dpp v16, v30, v8 row_newbcast:12 row_mask:0xf bank_mask:0xf
    v_and_b32_dpp v17, v30, v9 row_newbcast:12 row_mask:0xf bank_mask:0xf
    v_and_b32_dpp v18, v30, v10 row_newbcast:12 row_mask:0xf bank_mask:0xf
    v_and_b32_dpp v19, v30, v11 row_newbcast:12 row_mask:0xf bank_mask:0xf
    s_nop 1
    v_mfma_f32_16x16x32_bf16 v[12:15], v[16:19], v[76:79], v[12:15]
    s_waitcnt vmcnt(3)
    s_xor_b32 s17, s16, s18
    s_add_u32 s16, s16, 4096
    buffer_load_dwordx4 v[112:115], v1, s[12:15], s17 offen nt
    v_and_b32_dpp v16, v30, v8 row_newbcast:1 row_mask:0xf bank_mask:0xf
    v_and_b32_dpp v17, v30, v9 row_newbcast:1 row_mask:0xf bank_mask:0xf
    v_and_b32_dpp v18, v30, v10 row_newbcast:1 row_mask:0xf bank_mask:0xf
    v_and_b32_dpp v19, v30, v11 row_newbcast:1 row_mask:0xf bank_mask:0xf
    s_nop 1
    v_mfma_f32_16x16x32_bf16 v[12:15], v[16:19], v[80:83], v[12:15]
    s_waitcnt vmcnt(3)
    s_xor_b32 s17, s16, s18
    s_add_u32 s16, s16, 4096
    buffer_load_dwordx4 v[116:119], v1, s[12:15], s17 offen nt
    v_and_b32_dpp v16, v30, v8 row_newbcast:9 row_mask:0xf bank_mask:0xf
    v_and_b32_dpp v17, v30, v9 row_newbcast:9 row_mask:0xf bank_mask:0xf
    v_and_b32_dpp v18, v30, v10 row_newbcast:9 row_mask:0xf bank_mask:0xf
    v_and_b32_dpp v19, v30, v11 row_newbcast:9 row_mask:0xf bank_mask:0xf
    s_nop 1
    v_mfma_f32_16x16x32_bf16 v[12:15], v[16:19], v[84:87], v[12:15]
    s_waitcnt vmcnt(3)
    s_xor_b32 s17, s16, s18
    s_add_u32 s16, s16, 4096
    buffer_load_dwordx4 v[120:123], v1, s[12:15], s17 offen nt
    v_and_b32_dpp v16, v30, v8 row_newbcast:5 row_mask:0xf bank_mask:0xf
    v_and_b32_dpp v17, v30, v9 row_newbcast:5 row_mask:0xf bank_mask:0xf
    v_and_b32_dpp v18, v30, v10 row_newbcast:5 row_mask:0xf bank_mask:0xf
    v_and_b32_dpp v19, v30, v11 row_newbcast:5 row_mask:0xf bank_mask:0xf
    s_nop 1
    v_mfma_f32_16x16x32_bf16 v[12:15], v[16:19], v[88:91], v[12:15]
    s_waitcnt vmcnt(3)
    s_xor_b32 s17, s16, s18
    s_add_u32 s16, s16, 4096
    buffer_load_dwordx4 v[124:127], v1, s[12:15], s17 offen nt
    v_and_b32_dpp v16, v30, v8 row_newbcast:13 row_mask:0xf bank_mask:0xf
    v_and_b32_dpp v17, v30, v9 row_newbcast:13 row_mask:0xf bank_mask:0xf
    v_and_b32_dpp v18, v30, v10 row_newbcast:13 row_mask:0xf bank_mask:0xf
    v_and_b32_dpp v19, v30, v11 row_newbcast:13 row_mask:0xf bank_mask:0xf
    s_nop 1
    v_mfma_f32_16x16x32_bf16 v[12:15], v[16:19], v[92:95], v[12:15]
    s_waitcnt vmcnt(3)
    s_and_b32 s16, s16, 0x1fffff
    s_lshl_b32 s34, s16, 3
    s_and_b32 s34, s34, 0xe00000
    s_xor_b32 s34, s34, s35
    s_or_b32 s16, s16, s34
    s_xor_b32 s17, s16, s18
    s_add_u32 s16, s16, 4096
    buffer_load_dwordx4 v[64:67], v1, s[12:15], s17 offen nt
    v_and_b32_dpp v16, v30, v8 row_newbcast:2 row_mask:0xf bank_mask:0xf
    v_and_b32_dpp v17, v30, v9 row_newbcast:2 row_mask:0xf bank_mask:0xf
    v_and_b32_dpp v18, v30, v10 row_newbcast:2 row_mask:0xf bank_mask:0xf
    v_and_b32_dpp v19, v30, v11 row_newbcast:2 row_mask:0xf bank_mask:0xf
    s_nop 1
    v_mfma_f32_16x16x32_bf16 v[12:15], v[16:19], v[96:99], v[12:15]
    s_waitcnt vmcnt(3)
    s_xor_b32 s17, s16, s18
    s_add_u32 s16, s16, 4096
    buffer_load_dwordx4 v[68:71], v1, s[12:15], s17 offen nt
    v_and_b32_dpp v16, v30, v8 row_newbcast:10 row_mask:0xf bank_mask:0xf
    v_and_b32_dpp v17, v30, v9 row_newbcast:10 row_mask:0xf bank_mask:0xf
    v_and_b32_dpp v18, v30, v10 row_newbcast:10 row_mask:0xf bank_mask:0xf
    v_and_b32_dpp v19, v30, v11 row_newbcast:10 row_mask:0xf bank_mask:0xf
    s_nop 1
    v_mfma_f32_16x16x32_bf16 v[12:15], v[16:19], v[100:103], v[12:15]
    s_waitcnt vmcnt(3)
    s_xor_b32 s17, s16, s18
    s_add_u32 s16, s16, 4096
    buffer_load_dwordx4 v[72:75], v1, s[12:15], s17 offen nt
    v_and_b32_dpp v16, v30, v8 row_newbcast:6 row_mask:0xf bank_mask:0xf
    v_and_b32_dpp v17, v30, v9 row_newbcast:6 row_mask:0xf bank_mask:0xf
    v_and_b32_dpp v18, v30, v10 row_newbcast:6 row_mask:0xf bank_mask:0xf
    v_and_b32_dpp v19, v30, v11 row_newbcast:6 row_mask:0xf bank_mask:0xf
    s_nop 1
    v_mfma_f32_16x16x32_bf16 v[12:15], v[16:19], v[104:107], v[12:15]
    s_waitcnt vmcnt(3)
    s_xor_b32 s17, s16, s18
    s_add_u32 s16, s16, 4096
    buffer_load_dwordx4 v[76:79], v1, s[12:15], s17 offen nt
    v_and_b32_dpp v16, v30, v8 row_newbcast:14 row_mask:0xf bank_mask:0xf
    v_and_b32_dpp v17, v30, v9 row_newbcast:14 row_mask:0xf bank_mask:0xf
    v_and_b32_dpp v18, v30, v10 row_newbcast:14 row_mask:0xf bank_mask:0xf
    v_and_b32_dpp v19, v30, v11 row_newbcast:14 row_mask:0xf bank_mask:0xf
    s_nop 1
    v_mfma_f32_16x16x32_bf16 v[12:15], v[16:19], v[108:111], v[12:15]
    s_waitcnt vmcnt(3)
    s_xor_b32 s17, s16, s18
    s_add_u32 s16, s16, 4096
    buffer_load_dwordx4 v[80:83], v1, s[12:15], s17 offen nt
    v_and_b32_dpp v16, v30, v8 row_newbcast:3 row_mask:0xf bank_mask:0xf
    v_and_b32_dpp v17, v30, v9 row_newbcast:3 row_mask:0xf bank_mask:0xf
    v_and_b32_dpp v18, v30, v10 row_newbcast:3 row_mask:0xf bank_mask:0xf
    v_and_b32_dpp v19, v30, v11 row_newbcast:3 row_mask:0xf bank_mask:0xf
    s_nop 1
    v_mfma_f32_16x16x32_bf16 v[12:15], v[16:19], v[112:115], v[12:15]
    s_waitcnt vmcnt(3)
    s_xor_b32 s17, s16, s18
    s_add_u32 s16, s16, 4096
    buffer_load_dwordx4 v[84:87], v1, s[12:15], s17 offen nt
    v_and_b32_dpp v16, v30, v8 row_newbcast:11 row_mask:0xf bank_mask:0xf
    v_and_b32_dpp v17, v30, v9 row_newbcast:11 row_mask:0xf bank_mask:0xf
    v_and_b32_dpp v18, v30, v10 row_newbcast:11 row_mask:0xf bank_mask:0xf
    v_and_b32_dpp v19, v30, v11 row_newbcast:11 row_mask:0xf bank_mask:0xf
    s_nop 1
    v_mfma_f32_16x16x32_bf16 v[12:15], v[16:19], v[116:119], v[12:15]
    s_waitcnt vmcnt(3)
    s_xor_b32 s17, s16, s18
    s_add_u32 s16, s16, 4096
    buffer_load_dwordx4 v[88:91], v1, s[12:15], s17 offen nt
    v_and_b32_dpp v16, v30, v8 row_newbcast:7 row_mask:0xf bank_mask:0xf
    v_and_b32_dpp v17, v30, v9 row_newbcast:7 row_mask:0xf bank_mask:0xf
    v_and_b32_dpp v18, v30, v10 row_newbcast:7 row_mask:0xf bank_mask:0xf
    v_and_b32_dpp v19, v30, v11 row_newbcast:7 row_mask:0xf bank_mask:0xf
    s_nop 1
    v_mfma_f32_16x16x32_bf16 v[12:15], v[16:19], v[120:123], v[12:15]
    s_waitcnt vmcnt(3)
    s_xor_b32 s17, s16, s18
    s_add_u32 s16, s16, 4096
    buffer_load_dwordx4 v[92:95], v1, s[12:15], s17 offen nt
    v_and_b32_dpp v16, v30, v8 row_newbcast:15 row_mask:0xf bank_mask:0xf
    v_and_b32_dpp v17, v30, v9 row_newbcast:15 row_mask:0xf bank_mask:0xf
    v_and_b32_dpp v18, v30, v10 row_newbcast:15 row_mask:0xf bank_mask:0xf
    v_and_b32_dpp v19, v30, v11 row_newbcast:15 row_mask:0xf bank_mask:0xf
    s_nop 1
    v_mfma_f32_16x16x32_bf16 v[12:15], v[16:19], v[124:127], v[12:15]
    s_add_u32 s19, s19, 1
    s_cmp_lg_u32 s19, s47
    s_cbranch_scc1 L_vnarrow
L_vloop:
    s_waitcnt vmcnt(4)
    s_xor_b32 s17, s16, s18
    s_add_u32 s16, s16, 4096
    buffer_load_dwordx4 v[96:99], v1, s[12:15], s17 offen nt
    s_set_gpr_idx_on s19, gpr_idx(SRC0)
    s_nop 0
    v_mov_b32 v30, v32
    s_set_gpr_idx_off
    s_nop 0
    v_and_b32_dpp v16, v30, v8 row_newbcast:0 row_mask:0xf bank_mask:0xf
    v_and_b32_dpp v17, v30, v9 row_newbcast:0 row_mask:0xf bank_mask:0xf
    v_and_b32_dpp v18, v30, v10 row_newbcast:0 row_mask:0xf bank_mask:0xf
    v_and_b32_dpp v19, v30, v11 row_newbcast:0 row_mask:0xf bank_mask:0xf
    s_nop 1
    v_mfma_f32_16x16x32_bf16 v[12:15], v[16:19], v[64:67], v[12:15]
    s_waitcnt vmcnt(4)
    s_xor_b32 s17, s16, s18
    s_add_u32 s16, s16, 4096
    buffer_load_dwordx4 v[100:103], v1, s[12:15], s17 offen nt
    v_and_b32_dpp v16, v30, v8 row_newbcast:8 row_mask:0xf bank_mask:0xf
    v_and_b32_dpp v17, v30, v9 row_newbcast:8 row_mask:0xf bank_mask:0xf
    v_and_b32_dpp v18, v30, v10 row_newbcast:8 row_mask:0xf bank_mask:0xf
    v_and_b32_dpp v19, v30, v11 row_newbcast:8 row_mask:0xf bank_mask:0xf
    s_nop 1
    v_mfma_f32_16x16x32_bf16 v[12:15], v[16:19], v[68:71], v[12:15]
    s_waitcnt vmcnt(4)
    s_xor_b32 s17, s16, s18
    s_add_u32 s16, s16, 4096
    buffer_load_dwordx4 v[104:107], v1, s[12:15], s17 offen nt
    v_and_b32_dpp v16, v30, v8 row_newbcast:4 row_mask:0xf bank_mask:0xf
    v_and_b32_dpp v17, v30, v9 row_newbcast:4 row_mask:0xf bank_mask:0xf
    v_and_b32_dpp v18, v30, v10 row_newbcast:4 row_mask:0xf bank_mask:0xf
    v_and_b32_dpp v19, v30, v11 row_newbcast:4 row_mask:0xf bank_mask:0xf
    s_nop 1
    v_mfma_f32_16x16x32_bf16 v[12:15], v[16:19], v[72:75], v[12:15]
    s_waitcnt vmcnt(4)
    s_xor_b32 s17, s16, s18
    s_add_u32 s16, s16, 4096
    buffer_load_dwordx4 v[108:111], v1, s[12:15], s17 offen nt
    v_and_b32_dpp v16, v30, v8 row_newbcast:12 row_mask:0xf bank_mask:0xf
    v_and_b32_dpp v17, v30, v9 row_newbcast:12 row_mask:0xf bank_mask:0xf
    v_and_b32_dpp v18, v30, v10 row_newbcast:12 row_mask:0xf bank_mask:0xf
    v_and_b32_dpp v19, v30, v11 row_newbcast:12 row_mask:0xf bank_mask:0xf
    s_nop 1
    v_mfma_f32_16x16x32_bf16 v[12:15], v[16:19], v[76:79], v[12:15]
    s_waitcnt vmcnt(4)
    s_xor_b32 s17, s16, s18
    s_add_u32 s16, s16, 4096
    buffer_load_dwordx4 v[112:115], v1, s[12:15], s17 offen nt
    v_and_b32_dpp v16, v30, v8 row_newbcast:1 row_mask:0xf bank_mask:0xf
    v_and_b32_dpp v17, v30, v9 row_newbcast:1 row_mask:0xf bank_mask:0xf
    v_and_b32_dpp v18, v30, v10 row_newbcast:1 row_mask:0xf bank_mask:0xf
    v_and_b32_dpp v19, v30, v11 row_newbcast:1 row_mask:0xf bank_mask:0xf
    s_nop 1
    v_mfma_f32_16x16x32_bf16 v[12:15], v[16:19], v[80:83], v[12:15]
    s_waitcnt vmcnt(4)
    s_xor_b32 s17, s16, s18
    s_add_u32 s16, s16, 4096
    buffer_load_dwordx4 v[116:119], v1, s[12:15], s17 offen nt
    v_and_b32_dpp v16, v30, v8 row_newbcast:9 row_mask:0xf bank_mask:0xf
    v_and_b32_dpp v17, v30, v9 row_newbcast:9 row_mask:0xf bank_mask:0xf
    v_and_b32_dpp v18, v30, v10 row_newbcast:9 row_mask:0xf bank_mask:0xf
    v_and_b32_dpp v19, v30, v11 row_newbcast:9 row_mask:0xf bank_mask:0xf
    s_nop 1
    v_mfma_f32_16x16x32_bf16 v[12:15], v[16:19], v[84:87], v[12:15]
    s_waitcnt vmcnt(4)
    s_xor_b32 s17, s16, s18
    s_add_u32 s16, s16, 4096
    buffer_load_dwordx4 v[120:123], v1, s[12:15], s17 offen nt
    v_and_b32_dpp v16, v30, v8 row_newbcast:5 row_mask:0xf bank_mask:0xf
    v_and_b32_dpp v17, v30, v9 row_newbcast:5 row_mask:0xf bank_mask:0xf
    v_and_b32_dpp v18, v30, v10 row_newbcast:5 row_mask:0xf bank_mask:0xf
    v_and_b32_dpp v19, v30, v11 row_newbcast:5 row_mask:0xf bank_mask:0xf
    s_nop 1
    v_mfma_f32_16x16x32_bf16 v[12:15], v[16:19], v[88:91], v[12:15]
    s_waitcnt vmcnt(4)
    s_xor_b32 s17, s16, s18
    s_add_u32 s16, s16, 4096
    buffer_load_dwordx4 v[124:127], v1, s[12:15], s17 offen nt
    v_and_b32_dpp v16, v30, v8 row_newbcast:13 row_mask:0xf bank_mask:0xf
    v_and_b32_dpp v17, v30, v9 row_newbcast:13 row_mask:0xf bank_mask:0xf
    v_and_b32_dpp v18, v30, v10 row_newbcast:13 row_mask:0xf bank_mask:0xf
    v_and_b32_dpp v19, v30, v11 row_newbcast:13 row_mask:0xf bank_mask:0xf
    s_nop 1
    v_mfma_f32_16x16x32_bf16 v[12:15], v[16:19], v[92:95], v[12:15]
    s_waitcnt vmcnt(4)
    s_and_b32 s16, s16, 0x1fffff
    s_lshl_b32 s34, s16, 3
    s_and_b32 s34, s34, 0xe00000
    s_xor_b32 s34, s34, s35
    s_or_b32 s16, s16, s34
    s_xor_b32 s17, s16, s18
    s_add_u32 s16, s16, 4096
    buffer_load_dwordx4 v[64:67], v1, s[12:15], s17 offen nt
    v_and_b32_dpp v16, v30, v8 row_newbcast:2 row_mask:0xf bank_mask:0xf
    v_and_b32_dpp v17, v30, v9 row_newbcast:2 row_mask:0xf bank_mask:0xf
    v_and_b32_dpp v18, v30, v10 row_newbcast:2 row_mask:0xf bank_mask:0xf
    v_and_b32_dpp v19, v30, v11 row_newbcast:2 row_mask:0xf bank_mask:0xf
    s_nop 1
    v_mfma_f32_16x16x32_bf16 v[12:15], v[16:19], v[96:99], v[12:15]
    s_waitcnt vmcnt(4)
    s_xor_b32 s17, s16, s18
    s_add_u32 s16, s16, 4096
    buffer_load_dwordx4 v[68:71], v1, s[12:15], s17 offen nt
    v_and_b32_dpp v16, v30, v8 row_newbcast:10 row_mask:0xf bank_mask:0xf
    v_and_b32_dpp v17, v30, v9 row_newbcast:10 row_mask:0xf bank_mask:0xf
    v_and_b32_dpp v18, v30, v10 row_newbcast:10 row_mask:0xf bank_mask:0xf
    v_and_b32_dpp v19, v30, v11 row_newbcast:10 row_mask:0xf bank_mask:0xf
    s_nop 1
    v_mfma_f32_16x16x32_bf16 v[12:15], v[16:19], v[100:103], v[12:15]
    s_waitcnt vmcnt(4)
    s_xor_b32 s17, s16, s18
    s_add_u32 s16, s16, 4096
    buffer_load_dwordx4 v[72:75], v1, s[12:15], s17 offen nt
    v_and_b32_dpp v16, v30, v8 row_newbcast:6 row_mask:0xf bank_mask:0xf
    v_and_b32_dpp v17, v30, v9 row_newbcast:6 row_mask:0xf bank_mask:0xf
    v_and_b32_dpp v18, v30, v10 row_newbcast:6 row_mask:0xf bank_mask:0xf
    v_and_b32_dpp v19, v30, v11 row_newbcast:6 row_mask:0xf bank_mask:0xf
    s_nop 1
    v_mfma_f32_16x16x32_bf16 v[12:15], v[16:19], v[104:107], v[12:15]
    s_waitcnt vmcnt(4)
    s_xor_b32 s17, s16, s18
    s_add_u32 s16, s16, 4096
    buffer_load_dwordx4 v[76:79], v1, s[12:15], s17 offen nt
    v_and_b32_dpp v16, v30, v8 row_newbcast:14 row_mask:0xf bank_mask:0xf
    v_and_b32_dpp v17, v30, v9 row_newbcast:14 row_mask:0xf bank_mask:0xf
    v_and_b32_dpp v18, v30, v10 row_newbcast:14 row_mask:0xf bank_mask:0xf
    v_and_b32_dpp v19, v30, v11 row_newbcast:14 row_mask:0xf bank_mask:0xf
    s_nop 1
    v_mfma_f32_16x16x32_bf16 v[12:15], v[16:19], v[108:111], v[12:15]
    s_waitcnt vmcnt(4)
    s_xor_b32 s17, s16, s18
    s_add_u32 s16, s16, 4096
    buffer_load_dwordx4 v[80:83], v1, s[12:15], s17 offen nt
    v_and_b32_dpp v16, v30, v8 row_newbcast:3 row_mask:0xf bank_mask:0xf
    v_and_b32_dpp v17, v30, v9 row_newbcast:3 row_mask:0xf bank_mask:0xf
    v_and_b32_dpp v18, v30, v10 row_newbcast:3 row_mask:0xf bank_mask:0xf
    v_and_b32_dpp v19, v30, v11 row_newbcast:3 row_mask:0xf bank_mask:0xf
    s_nop 1
    v_mfma_f32_16x16x32_bf16 v[12:15], v[16:19], v[112:115], v[12:15]
    s_waitcnt vmcnt(4)
    s_xor_b32 s17, s16, s18
    s_add_u32 s16, s16, 4096
    buffer_load_dwordx4 v[84:87], v1, s[12:15], s17 offen nt
    v_and_b32_dpp v16, v30, v8 row_newbcast:11 row_mask:0xf bank_mask:0xf
    v_and_b32_dpp v17, v30, v9 row_newbcast:11 row_mask:0xf bank_mask:0xf
    v_and_b32_dpp v18, v30, v10 row_newbcast:11 row_mask:0xf bank_mask:0xf
    v_and_b32_dpp v19, v30, v11 row_newbcast:11 row_mask:0xf bank_mask:0xf
    s_nop 1
    v_mfma_f32_16x16x32_bf16 v[12:15], v[16:19], v[116:119], v[12:15]
    s_waitcnt vmcnt(4)
    s_xor_b32 s17, s16, s18
    s_add_u32 s16, s16, 4096
    buffer_load_dwordx4 v[88:91], v1, s[12:15], s17 offen nt
    v_and_b32_dpp v16, v30, v8 row_newbcast:7 row_mask:0xf bank_mask:0xf
    v_and_b32_dpp v17, v30, v9 row_newbcast:7 row_mask:0xf bank_mask:0xf
    v_and_b32_dpp v18, v30, v10 row_newbcast:7 row_mask:0xf bank_mask:0xf
    v_and_b32_dpp v19, v30, v11 row_newbcast:7 row_mask:0xf bank_mask:0xf
    s_nop 1
    v_mfma_f32_16x16x32_bf16 v[12:15], v[16:19], v[120:123], v[12:15]
    s_waitcnt vmcnt(4)
    s_xor_b32 s17, s16, s18
    s_add_u32 s16, s16, 4096
    buffer_load_dwordx4 v[92:95], v1, s[12:15], s17 offen nt
    v_and_b32_dpp v16, v30, v8 row_newbcast:15 row_mask:0xf bank_mask:0xf
    v_and_b32_dpp v17, v30, v9 row_newbcast:15 row_mask:0xf bank_mask:0xf
    v_and_b32_dpp v18, v30, v10 row_newbcast:15 row_mask:0xf bank_mask:0xf
    v_and_b32_dpp v19, v30, v11 row_newbcast:15 row_mask:0xf bank_mask:0xf
    s_nop 1
    v_mfma_f32_16x16x32_bf16 v[12:15], v[16:19], v[124:127], v[12:15]
    s_add_u32 s19, s19, 1
    s_cmp_lg_u32 s19, 30
    s_cbranch_scc1 L_vloop
    s_mov_b32 s19, 30
L_vlate:
    s_waitcnt vmcnt(7)
    s_xor_b32 s17, s16, s18
    s_add_u32 s16, s16, 4096
    buffer_load_dwordx4 v[96:99], v1, s[12:15], s17 offen nt
    s_set_gpr_idx_on s19, gpr_idx(SRC0)
    s_nop 0
    v_mov_b32 v30, v32
    s_set_gpr_idx_off
    s_nop 0
    v_and_b32_dpp v16, v30, v8 row_newbcast:0 row_mask:0xf bank_mask:0xf
    v_and_b32_dpp v17, v30, v9 row_newbcast:0 row_mask:0xf bank_mask:0xf
    v_and_b32_dpp v18, v30, v10 row_newbcast:0 row_mask:0xf bank_mask:0xf
    v_and_b32_dpp v19, v30, v11 row_newbcast:0 row_mask:0xf bank_mask:0xf
    s_nop 1
    v_mfma_f32_16x16x32_bf16 v[12:15], v[16:19], v[64:67], v[12:15]
    s_waitcnt vmcnt(7)
    s_xor_b32 s17, s16, s18
    s_add_u32 s16, s16, 4096
    buffer_load_dwordx4 v[100:103], v1, s[12:15], s17 offen nt
    v_and_b32_dpp v16, v30, v8 row_newbcast:8 row_mask:0xf bank_mask:0xf
    v_and_b32_dpp v17, v30, v9 row_newbcast:8 row_mask:0xf bank_mask:0xf
    v_and_b32_dpp v18, v30, v10 row_newbcast:8 row_mask:0xf bank_mask:0xf
    v_and_b32_dpp v19, v30, v11 row_newbcast:8 row_mask:0xf bank_mask:0xf
    s_nop 1
    v_mfma_f32_16x16x32_bf16 v[12:15], v[16:19], v[68:71], v[12:15]
    s_waitcnt vmcnt(7)
    s_xor_b32 s17, s16, s18
    s_add_u32 s16, s16, 4096
    buffer_load_dwordx4 v[104:107], v1, s[12:15], s17 offen nt
    v_and_b32_dpp v16, v30, v8 row_newbcast:4 row_mask:0xf bank_mask:0xf
    v_and_b32_dpp v17, v30, v9 row_newbcast:4 row_mask:0xf bank_mask:0xf
    v_and_b32_dpp v18, v30, v10 row_newbcast:4 row_mask:0xf bank_mask:0xf
    v_and_b32_dpp v19, v30, v11 row_newbcast:4 row_mask:0xf bank_mask:0xf
    s_nop 1
    v_mfma_f32_16x16x32_bf16 v[12:15], v[16:19], v[72:75], v[12:15]
    s_waitcnt vmcnt(7)
    s_xor_b32 s17, s16, s18
    s_add_u32 s16, s16, 4096
    buffer_load_dwordx4 v[108:111], v1, s[12:15], s17 offen nt
    v_and_b32_dpp v16, v30, v8 row_newbcast:12 row_mask:0xf bank_mask:0xf
    v_and_b32_dpp v17, v30, v9 row_newbcast:12 row_mask:0xf bank_mask:0xf
    v_and_b32_dpp v18, v30, v10 row_newbcast:12 row_mask:0xf bank_mask:0xf
    v_and_b32_dpp v19, v30, v11 row_newbcast:12 row_mask:0xf bank_mask:0xf
    s_nop 1
    v_mfma_f32_16x16x32_bf16 v[12:15], v[16:19], v[76:79], v[12:15]
    s_waitcnt vmcnt(7)
    s_xor_b32 s17, s16, s18
    s_add_u32 s16, s16, 4096
    buffer_load_dwordx4 v[112:115], v1, s[12:15], s17 offen nt
    v_and_b32_dpp v16, v30, v8 row_newbcast:1 row_mask:0xf bank_mask:0xf
    v_and_b32_dpp v17, v30, v9 row_newbcast:1 row_mask:0xf bank_mask:0xf
    v_and_b32_dpp v18, v30, v10 row_newbcast:1 row_mask:0xf bank_mask:0xf
    v_and_b32_dpp v19, v30, v11 row_newbcast:1 row_mask:0xf bank_mask:0xf
    s_nop 1
    v_mfma_f32_16x16x32_bf16 v[12:15], v[16:19], v[80:83], v[12:15]
    s_waitcnt vmcnt(7)
    s_xor_b32 s17, s16, s18
    s_add_u32 s16, s16, 4096
    buffer_load_dwordx4 v[116:119], v1, s[12:15], s17 offen nt
    v_and_b32_dpp v16, v30, v8 row_newbcast:9 row_mask:0xf bank_mask:0xf
    v_and_b32_dpp v17, v30, v9 row_newbcast:9 row_mask:0xf bank_mask:0xf
    v_and_b32_dpp v18, v30, v10 row_newbcast:9 row_mask:0xf bank_mask:0xf
    v_and_b32_dpp v19, v30, v11 row_newbcast:9 row_mask:0xf bank_mask:0xf
    s_nop 1
    v_mfma_f32_16x16x32_bf16 v[12:15], v[16:19], v[84:87], v[12:15]
    s_waitcnt vmcnt(7)
    s_xor_b32 s17, s16, s18
    s_add_u32 s16, s16, 4096
    buffer_load_dwordx4 v[120:123], v1, s[12:15], s17 offen nt
    v_and_b32_dpp v16, v30, v8 row_newbcast:5 row_mask:0xf bank_mask:0xf
    v_and_b32_dpp v17, v30, v9 row_newbcast:5 row_mask:0xf bank_mask:0xf
    v_and_b32_dpp v18, v30, v10 row_newbcast:5 row_mask:0xf bank_mask:0xf
    v_and_b32_dpp v19, v30, v11 row_newbcast:5 row_mask:0xf bank_mask:0xf
    s_nop 1
    v_mfma_f32_16x16x32_bf16 v[12:15], v[16:19], v[88:91], v[12:15]
    s_waitcnt vmcnt(7)
    s_xor_b32 s17, s16, s18
    s_add_u32 s16, s16, 4096
    buffer_load_dwordx4 v[124:127], v1, s[12:15], s17 offen nt
    v_and_b32_dpp v16, v30, v8 row_newbcast:13 row_mask:0xf bank_mask:0xf
    v_and_b32_dpp v17, v30, v9 row_newbcast:13 row_mask:0xf bank_mask:0xf
    v_and_b32_dpp v18, v30, v10 row_newbcast:13 row_mask:0xf bank_mask:0xf
    v_and_b32_dpp v19, v30, v11 row_newbcast:13 row_mask:0xf bank_mask:0xf
    s_nop 1
    v_mfma_f32_16x16x32_bf16 v[12:15], v[16:19], v[92:95], v[12:15]
    s_waitcnt vmcnt(7)
    s_and_b32 s16, s16, 0x1fffff
    s_lshl_b32 s34, s16, 3
    s_and_b32 s34, s34, 0xe00000
    s_xor_b32 s34, s34, s35
    s_or_b32 s16, s16, s34
    s_xor_b32 s17, s16, s18
    s_add_u32 s16, s16, 4096
    buffer_load_dwordx4 v[64:67], v1, s[12:15], s17 offen nt
    v_and_b32_dpp v16, v30, v8 row_newbcast:2 row_mask:0xf bank_mask:0xf
    v_and_b32_dpp v17, v30, v9 row_newbcast:2 row_mask:0xf bank_mask:0xf
    v_and_b32_dpp v18, v30, v10 row_newbcast:2 row_mask:0xf bank_mask:0xf
    v_and_b32_dpp v19, v30, v11 row_newbcast:2 row_mask:0xf bank_mask:0xf
    s_nop 1
    v_mfma_f32_16x16x32_bf16 v[12:15], v[16:19], v[96:99], v[12:15]
    s_waitcnt vmcnt(7)
    s_xor_b32 s17, s16, s18
    s_add_u32 s16, s16, 4096
    buffer_load_dwordx4 v[68:71], v1, s[12:15], s17 offen nt
    v_and_b32_dpp v16, v30, v8 row_newbcast:10 row_mask:0xf bank_mask:0xf
    v_and_b32_dpp v17, v30, v9 row_newbcast:10 row_mask:0xf bank_mask:0xf
    v_and_b32_dpp v18, v30, v10 row_newbcast:10 row_mask:0xf bank_mask:0xf
    v_and_b32_dpp v19, v30, v11 row_newbcast:10 row_mask:0xf bank_mask:0xf
    s_nop 1
    v_mfma_f32_16x16x32_bf16 v[12:15], v[16:19], v[100:103], v[12:15]
    s_waitcnt vmcnt(7)
    s_xor_b32 s17, s16, s18
    s_add_u32 s16, s16, 4096
    buffer_load_dwordx4 v[72:75], v1, s[12:15], s17 offen nt
    v_and_b32_dpp v16, v30, v8 row_newbcast:6 row_mask:0xf bank_mask:0xf
    v_and_b32_dpp v17, v30, v9 row_newbcast:6 row_mask:0xf bank_mask:0xf
    v_and_b32_dpp v18, v30, v10 row_newbcast:6 row_mask:0xf bank_mask:0xf
    v_and_b32_dpp v19, v30, v11 row_newbcast:6 row_mask:0xf bank_mask:0xf
    s_nop 1
    v_mfma_f32_16x16x32_bf16 v[12:15], v[16:19], v[104:107], v[12:15]
    s_waitcnt vmcnt(7)
    s_xor_b32 s17, s16, s18
    s_add_u32 s16, s16, 4096
    buffer_load_dwordx4 v[76:79], v1, s[12:15], s17 offen nt
    v_and_b32_dpp v16, v30, v8 row_newbcast:14 row_mask:0xf bank_mask:0xf
    v_and_b32_dpp v17, v30, v9 row_newbcast:14 row_mask:0xf bank_mask:0xf
    v_and_b32_dpp v18, v30, v10 row_newbcast:14 row_mask:0xf bank_mask:0xf
    v_and_b32_dpp v19, v30, v11 row_newbcast:14 row_mask:0xf bank_mask:0xf
    s_nop 1
    v_mfma_f32_16x16x32_bf16 v[12:15], v[16:19], v[108:111], v[12:15]
    s_waitcnt vmcnt(7)
    s_xor_b32 s17, s16, s18
    s_add_u32 s16, s16, 4096
    buffer_load_dwordx4 v[80:83], v1, s[12:15], s17 offen nt
    v_and_b32_dpp v16, v30, v8 row_newbcast:3 row_mask:0xf bank_mask:0xf
    v_and_b32_dpp v17, v30, v9 row_newbcast:3 row_mask:0xf bank_mask:0xf
    v_and_b32_dpp v18, v30, v10 row_newbcast:3 row_mask:0xf bank_mask:0xf
    v_and_b32_dpp v19, v30, v11 row_newbcast:3 row_mask:0xf bank_mask:0xf
    s_nop 1
    v_mfma_f32_16x16x32_bf16 v[12:15], v[16:19], v[112:115], v[12:15]
    s_waitcnt vmcnt(7)
    s_xor_b32 s17, s16, s18
    s_add_u32 s16, s16, 4096
    buffer_load_dwordx4 v[84:87], v1, s[12:15], s17 offen nt
    v_and_b32_dpp v16, v30, v8 row_newbcast:11 row_mask:0xf bank_mask:0xf
    v_and_b32_dpp v17, v30, v9 row_newbcast:11 row_mask:0xf bank_mask:0xf
    v_and_b32_dpp v18, v30, v10 row_newbcast:11 row_mask:0xf bank_mask:0xf
    v_and_b32_dpp v19, v30, v11 row_newbcast:11 row_mask:0xf bank_mask:0xf
    s_nop 1
    v_mfma_f32_16x16x32_bf16 v[12:15], v[16:19], v[116:119], v[12:15]
    s_waitcnt vmcnt(7)
    s_xor_b32 s17, s16, s18
    s_add_u32 s16, s16, 4096
    buffer_load_dwordx4 v[88:91], v1, s[12:15], s17 offen nt
    v_and_b32_dpp v16, v30, v8 row_newbcast:7 row_mask:0xf bank_mask:0xf
    v_and_b32_dpp v17, v30, v9 row_newbcast:7 row_mask:0xf bank_mask:0xf
    v_and_b32_dpp v18, v30, v10 row_newbcast:7 row_mask:0xf bank_mask:0xf
    v_and_b32_dpp v19, v30, v11 row_newbcast:7 row_mask:0xf bank_mask:0xf
    s_nop 1
    v_mfma_f32_16x16x32_bf16 v[12:15], v[16:19], v[120:123], v[12:15]
    s_waitcnt vmcnt(7)
    s_xor_b32 s17, s16, s18
    s_add_u32 s16, s16, 4096
    buffer_load_dwordx4 v[92:95], v1, s[12:15], s17 offen nt
    v_and_b32_dpp v16, v30, v8 row_newbcast:15 row_mask:0xf bank_mask:0xf
    v_and_b32_dpp v17, v30, v9 row_newbcast:15 row_mask:0xf bank_mask:0xf
    v_and_b32_dpp v18, v30, v10 row_newbcast:15 row_mask:0xf bank_mask:0xf
    v_and_b32_dpp v19, v30, v11 row_newbcast:15 row_mask:0xf bank_mask:0xf
    s_nop 1
    v_mfma_f32_16x16x32_bf16 v[12:15], v[16:19], v[124:127], v[12:15]
    s_add_u32 s19, s19, 1
    s_cmp_lg_u32 s19, 31
    s_cbranch_scc1 L_vlate
    s_waitcnt vmcnt(7)
    s_xor_b32 s17, s16, s18
    s_add_u32 s16, s16, 4096
    buffer_load_dwordx4 v[96:99], v1, s[12:15], s17 offen nt
    v_and_b32_dpp v16, v63, v8 row_newbcast:0 row_mask:0xf bank_mask:0xf
    v_and_b32_dpp v17, v63, v9 row_newbcast:0 row_mask:0xf bank_mask:0xf
    v_and_b32_dpp v18, v63, v10 row_newbcast:0 row_mask:0xf bank_mask:0xf
    v_and_b32_dpp v19, v63, v11 row_newbcast:0 row_mask:0xf bank_mask:0xf
    s_nop 1
    v_mfma_f32_16x16x32_bf16 v[12:15], v[16:19], v[64:67], v[12:15]
    s_waitcnt vmcnt(7)
    s_xor_b32 s17, s16, s18
    s_add_u32 s16, s16, 4096
    buffer_load_dwordx4 v[100:103], v1, s[12:15], s17 offen nt
    v_and_b32_dpp v16, v63, v8 row_newbcast:8 row_mask:0xf bank_mask:0xf
    v_and_b32_dpp v17, v63, v9 row_newbcast:8 row_mask:0xf bank_mask:0xf
    v_and_b32_dpp v18, v63, v10 row_newbcast:8 row_mask:0xf bank_mask:0xf
    v_and_b32_dpp v19, v63, v11 row_newbcast:8 row_mask:0xf bank_mask:0xf
    s_nop 1
    v_mfma_f32_16x16x32_bf16 v[12:15], v[16:19], v[68:71], v[12:15]
    s_waitcnt vmcnt(7)
    s_xor_b32 s17, s16, s18
    s_add_u32 s16, s16, 4096
    buffer_load_dwordx4 v[104:107], v1, s[12:15], s17 offen nt
    v_and_b32_dpp v16, v63, v8 row_newbcast:4 row_mask:0xf bank_mask:0xf
    v_and_b32_dpp v17, v63, v9 row_newbcast:4 row_mask:0xf bank_mask:0xf
    v_and_b32_dpp v18, v63, v10 row_newbcast:4 row_mask:0xf bank_mask:0xf
    v_and_b32_dpp v19, v63, v11 row_newbcast:4 row_mask:0xf bank_mask:0xf
    s_nop 1
    v_mfma_f32_16x16x32_bf16 v[12:15], v[16:19], v[72:75], v[12:15]
    s_waitcnt vmcnt(7)
    s_xor_b32 s17, s16, s18
    s_add_u32 s16, s16, 4096
    buffer_load_dwordx4 v[108:111], v1, s[12:15], s17 offen nt
    v_and_b32_dpp v16, v63, v8 row_newbcast:12 row_mask:0xf bank_mask:0xf
    v_and_b32_dpp v17, v63, v9 row_newbcast:12 row_mask:0xf bank_mask:0xf
    v_and_b32_dpp v18, v63, v10 row_newbcast:12 row_mask:0xf bank_mask:0xf
    v_and_b32_dpp v19, v63, v11 row_newbcast:12 row_mask:0xf bank_mask:0xf
    s_nop 1
    v_mfma_f32_16x16x32_bf16 v[12:15], v[16:19], v[76:79], v[12:15]
    s_waitcnt vmcnt(7)
    s_xor_b32 s17, s16, s18
    s_add_u32 s16, s16, 4096
    buffer_load_dwordx4 v[112:115], v1, s[12:15], s17 offen nt
    v_and_b32_dpp v16, v63, v8 row_newbcast:1 row_mask:0xf bank_mask:0xf
    v_and_b32_dpp v17, v63, v9 row_newbcast:1 row_mask:0xf bank_mask:0xf
    v_and_b32_dpp v18, v63, v10 row_newbcast:1 row_mask:0xf bank_mask:0xf
    v_and_b32_dpp v19, v63, v11 row_newbcast:1 row_mask:0xf bank_mask:0xf
    s_nop 1
    v_mfma_f32_16x16x32_bf16 v[12:15], v[16:19], v[80:83], v[12:15]
    s_waitcnt vmcnt(7)
    s_xor_b32 s17, s16, s18
    s_add_u32 s16, s16, 4096
    buffer_load_dwordx4 v[116:119], v1, s[12:15], s17 offen nt
    v_and_b32_dpp v16, v63, v8 row_newbcast:9 row_mask:0xf bank_mask:0xf
    v_and_b32_dpp v17, v63, v9 row_newbcast:9 row_mask:0xf bank_mask:0xf
    v_and_b32_dpp v18, v63, v10 row_newbcast:9 row_mask:0xf bank_mask:0xf
    v_and_b32_dpp v19, v63, v11 row_newbcast:9 row_mask:0xf bank_mask:0xf
    s_nop 1
    v_mfma_f32_16x16x32_bf16 v[12:15], v[16:19], v[84:87], v[12:15]
    s_waitcnt vmcnt(7)
    s_xor_b32 s17, s16, s18
    s_add_u32 s16, s16, 4096
    buffer_load_dwordx4 v[120:123], v1, s[12:15], s17 offen nt
    v_and_b32_dpp v16, v63, v8 row_newbcast:5 row_mask:0xf bank_mask:0xf
    v_and_b32_dpp v17, v63, v9 row_newbcast:5 row_mask:0xf bank_mask:0xf
    v_and_b32_dpp v18, v63, v10 row_newbcast:5 row_mask:0xf bank_mask:0xf
    v_and_b32_dpp v19, v63, v11 row_newbcast:5 row_mask:0xf bank_mask:0xf
    s_nop 1
    v_mfma_f32_16x16x32_bf16 v[12:15], v[16:19], v[88:91], v[12:15]
    s_waitcnt vmcnt(7)
    s_xor_b32 s17, s16, s18
    s_add_u32 s16, s16, 4096
    buffer_load_dwordx4 v[124:127], v1, s[12:15], s17 offen nt
    v_and_b32_dpp v16, v63, v8 row_newbcast:13 row_mask:0xf bank_mask:0xf
    v_and_b32_dpp v17, v63, v9 row_newbcast:13 row_mask:0xf bank_mask:0xf
    v_and_b32_dpp v18, v63, v10 row_newbcast:13 row_mask:0xf bank_mask:0xf
    v_and_b32_dpp v19, v63, v11 row_newbcast:13 row_mask:0xf bank_mask:0xf
    s_nop 1
    v_mfma_f32_16x16x32_bf16 v[12:15], v[16:19], v[92:95], v[12:15]
    s_waitcnt vmcnt(7)
    v_and_b32_dpp v16, v63, v8 row_newbcast:2 row_mask:0xf bank_mask:0xf
    v_and_b32_dpp v17, v63, v9 row_newbcast:2 row_mask:0xf bank_mask:0xf
    v_and_b32_dpp v18, v63, v10 row_newbcast:2 row_mask:0xf bank_mask:0xf
    v_and_b32_dpp v19, v63, v11 row_newbcast:2 row_mask:0xf bank_mask:0xf
    s_nop 1
    v_mfma_f32_16x16x32_bf16 v[12:15], v[16:19], v[96:99], v[12:15]
    s_waitcnt vmcnt(6)
    v_and_b32_dpp v16, v63, v8 row_newbcast:10 row_mask:0xf bank_mask:0xf
    v_and_b32_dpp v17, v63, v9 row_newbcast:10 row_mask:0xf bank_mask:0xf
    v_and_b32_dpp v18, v63, v10 row_newbcast:10 row_mask:0xf bank_mask:0xf
    v_and_b32_dpp v19, v63, v11 row_newbcast:10 row_mask:0xf bank_mask:0xf
    s_nop 1
    v_mfma_f32_16x16x32_bf16 v[12:15], v[16:19], v[100:103], v[12:15]
    s_waitcnt vmcnt(5)
    v_and_b32_dpp v16, v63, v8 row_newbcast:6 row_mask:0xf bank_mask:0xf
    v_and_b32_dpp v17, v63, v9 row_newbcast:6 row_mask:0xf bank_mask:0xf
    v_and_b32_dpp v18, v63, v10 row_newbcast:6 row_mask:0xf bank_mask:0xf
    v_and_b32_dpp v19, v63, v11 row_newbcast:6 row_mask:0xf bank_mask:0xf
    s_nop 1
    v_mfma_f32_16x16x32_bf16 v[12:15], v[16:19], v[104:107], v[12:15]
    s_waitcnt vmcnt(4)
    v_and_b32_dpp v16, v63, v8 row_newbcast:14 row_mask:0xf bank_mask:0xf
    v_and_b32_dpp v17, v63, v9 row_newbcast:14 row_mask:0xf bank_mask:0xf
    v_and_b32_dpp v18, v63, v10 row_newbcast:14 row_mask:0xf bank_mask:0xf
    v_and_b32_dpp v19, v63, v11 row_newbcast:14 row_mask:0xf bank_mask:0xf
    s_nop 1
    v_mfma_f32_16x16x32_bf16 v[12:15], v[16:19], v[108:111], v[12:15]
    s_waitcnt vmcnt(3)
    v_and_b32_dpp v16, v63, v8 row_newbcast:3 row_mask:0xf bank_mask:0xf
    v_and_b32_dpp v17, v63, v9 row_newbcast:3 row_mask:0xf bank_mask:0xf
    v_and_b32_dpp v18, v63, v10 row_newbcast:3 row_mask:0xf bank_mask:0xf
    v_and_b32_dpp v19, v63, v11 row_newbcast:3 row_mask:0xf bank_mask:0xf
    s_nop 1
    v_mfma_f32_16x16x32_bf16 v[12:15], v[16:19], v[112:115], v[12:15]
    s_waitcnt vmcnt(2)
    v_and_b32_dpp v16, v63, v8 row_newbcast:11 row_mask:0xf bank_mask:0xf
    v_and_b32_dpp v17, v63, v9 row_newbcast:11 row_mask:0xf bank_mask:0xf
    v_and_b32_dpp v18, v63, v10 row_newbcast:11 row_mask:0xf bank_mask:0xf
    v_and_b32_dpp v19, v63, v11 row_newbcast:11 row_mask:0xf bank_mask:0xf
    s_nop 1
    v_mfma_f32_16x16x32_bf16 v[12:15], v[16:19], v[116:119], v[12:15]
    s_waitcnt vmcnt(1)
    v_and_b32_dpp v16, v63, v8 row_newbcast:7 row_mask:0xf bank_mask:0xf
    v_and_b32_dpp v17, v63, v9 row_newbcast:7 row_mask:0xf bank_mask:0xf
    v_and_b32_dpp v18, v63, v10 row_newbcast:7 row_mask:0xf bank_mask:0xf
    v_and_b32_dpp v19, v63, v11 row_newbcast:7 row_mask:0xf bank_mask:0xf
    s_nop 1
    v_mfma_f32_16x16x32_bf16 v[12:15], v[16:19], v[120:123], v[12:15]
    s_waitcnt vmcnt(0)
    v_and_b32_dpp v16, v63, v8 row_newbcast:15 row_mask:0xf bank_mask:0xf
    v_and_b32_dpp v17, v63, v9 row_newbcast:15 row_mask:0xf bank_mask:0xf
    v_and_b32_dpp v18, v63, v10 row_newbcast:15 row_mask:0xf bank_mask:0xf
    v_and_b32_dpp v19, v63, v11 row_newbcast:15 row_mask:0xf bank_mask:0xf
    s_nop 1
    v_mfma_f32_16x16x32_bf16 v[12:15], v[16:19], v[124:127], v[12:15]
    s_mov_b32 exec_hi, 0
    s_nop 6
    ds_write_b128 v31, v[12:15] offset:4096
    s_waitcnt lgkmcnt(0)
    s_barrier
    s_endpgm
L_helper:
    s_load_dwordx2 s[40:41], s[0:1], 0
    s_load_dwordx4 s[44:47], s[0:1], 24
    s_load_dwordx2 s[56:57], s[0:1], 80
    s_load_dwordx4 s[48:51], s[0:1], 48
    s_load_dwordx4 s[52:55], s[0:1], 64
    s_sub_u32 s58, s3, 4
    v_lshlrev_b32 v1, 4, v0
    v_lshrrev_b32 v15, 4, v0
    v_and_b32 v14, 15, v0
    v_lshlrev_b32 v14, 4, v14
    v_lshl_add_u32 v14, v15, 15, v14
    v_lshlrev_b32 v15, 4, v15
    s_and_b32 s60, s5, 7
    s_lshl_b32 s59, s60, 8
    v_add_u32 v15, s59, v15
    s_lshl_b32 s59, s60, 19
    s_lshl_b32 s61, s7, 8
    s_add_u32 s59, s59, s61
    s_mov_b32 s63, 0x100000
    s_waitcnt lgkmcnt(0)
    s_load_dword s43, s[56:57], 425984
    s_mov_b32 s8, s40
    s_mov_b32 s9, s41
    s_mov_b32 s10, 1024
    s_mov_b32 s11, 0x20000
    s_mov_b32 s12, s44
    s_mov_b32 s13, s45
    s_mov_b32 s14, 4194304
    s_mov_b32 s15, 0x20000
    s_cmp_lg_u32 s58, 0
    s_cbranch_scc1 L_noq
    buffer_load_dwordx4 v[2:5], v1, s[8:11], 0 offen
    buffer_load_dwordx4 v[28:31], v14, s[12:15], s59 offen nt
    s_add_u32 s59, s59, 8192
    buffer_load_dwordx4 v[32:35], v14, s[12:15], s59 offen nt
    s_add_u32 s59, s59, 8192
    buffer_load_dwordx4 v[36:39], v14, s[12:15], s59 offen nt
    s_add_u32 s59, s59, 8192
    buffer_load_dwordx4 v[40:43], v14, s[12:15], s59 offen nt
    s_add_u32 s59, s59, 106496
    buffer_load_dwordx4 v[44:47], v14, s[12:15], s59 offen nt
    s_add_u32 s59, s59, 8192
    buffer_load_dwordx4 v[48:51], v14, s[12:15], s59 offen nt
    s_add_u32 s59, s59, 8192
    buffer_load_dwordx4 v[52:55], v14, s[12:15], s59 offen nt
    s_add_u32 s59, s59, 8192
    buffer_load_dwordx4 v[56:59], v14, s[12:15], s59 offen nt
    s_add_u32 s59, s59, 106496
    buffer_load_dwordx4 v[60:63], v14, s[12:15], s59 offen nt
    s_add_u32 s59, s59, 8192
    buffer_load_dwordx4 v[64:67], v14, s[12:15], s59 offen nt
    s_add_u32 s59, s59, 8192
    buffer_load_dwordx4 v[68:71], v14, s[12:15], s59 offen nt
    s_add_u32 s59, s59, 8192
    buffer_load_dwordx4 v[72:75], v14, s[12:15], s59 offen nt
    s_add_u32 s59, s59, 106496
    buffer_load_dwordx4 v[76:79], v14, s[12:15], s59 offen nt
    s_add_u32 s59, s59, 8192
    buffer_load_dwordx4 v[80:83], v14, s[12:15], s59 offen nt
    s_add_u32 s59, s59, 8192
    buffer_load_dwordx4 v[84:87], v14, s[12:15], s59 offen nt
    s_add_u32 s59, s59, 8192
    buffer_load_dwordx4 v[88:91], v14, s[12:15], s59 offen nt
L_noq:
    s_mov_b32 s16, s46
    s_mov_b32 s17, s47
    s_mov_b32 s18, 4194304
    s_mov_b32 s19, 0x20000
    s_mov_b32 s20, s48
    s_mov_b32 s21, s49
    s_mov_b32 s22, 1835008
    s_mov_b32 s23, 0x20000
    s_mov_b32 s24, s50
    s_mov_b32 s25, s51
    s_mov_b32 s26, 1835008
    s_mov_b32 s27, 0x20000
    s_mov_b32 s28, s52
    s_mov_b32 s29, s53
    s_mov_b32 s30, 1024
    s_mov_b32 s31, 0x20000
    s_mov_b32 s32, s54
    s_mov_b32 s33, s55
    s_mov_b32 s34, 256
    s_mov_b32 s35, 0x20000
    s_mov_b32 s36, s56
    s_mov_b32 s37, s57
    s_mov_b32 s38, 426112
    s_mov_b32 s39, 0x20000
    s_lshr_b32 s56, s2, 1
    s_bitcmp1_b32 s2, 0
    s_cselect_b32 s56, s56, 255
    s_lshl_b32 s53, s6, 9
    s_lshl_b32 s42, s6, 7
    s_add_u32 s42, s42, 131072
    s_bfe_u32 s54, s5, 0x20001
    s_lshl_b32 s54, s54, 14
    s_lshl_b32 s61, s7, 9
    s_add_u32 s54, s54, s61
    s_and_b32 s61, s5, 1
    s_lshl_b32 s61, s61, 8
    s_add_u32 s54, s54, s61
    s_add_u32 s54, s54, 163840
    s_lshl_b32 s52, s56, 9
    s_add_u32 s52, s52, 229376
    s_cmp_lt_u32 s56, 28
    s_cselect_b32 s52, s52, 0x40000000
    s_cmp_lg_u32 s58, 0
    s_cbranch_scc1 L_qdone
    v_mov_b32 v16, -1
    v_mov_b32 v17, -1
    v_lshlrev_b32 v11, 3, v0
    v_lshlrev_b32 v12, 2, v0
    v_mov_b32 v10, 0
    buffer_store_dwordx2 v[16:17], v11, s[36:39], s53 offen sc1
    buffer_store_dword v16, v12, s[36:39], s54 offen sc1
    s_mov_b64 exec, 1
    buffer_store_dwordx2 v[16:17], v10, s[36:39], s42 offen sc1
    s_mov_b64 exec, -1
    s_add_u32 s61, s52, 0
    buffer_store_dwordx2 v[16:17], v11, s[36:39], s61 offen sc1
    s_add_u32 s61, s52, 16384
    buffer_store_dwordx2 v[16:17], v11, s[36:39], s61 offen sc1
    s_add_u32 s61, s52, 32768
    buffer_store_dwordx2 v[16:17], v11, s[36:39], s61 offen sc1
    s_add_u32 s61, s52, 49152
    buffer_store_dwordx2 v[16:17], v11, s[36:39], s61 offen sc1
    v_and_b32 v10, 1, v0
    v_cmp_eq_u32 vcc, 1, v10
    v_mov_b32 v11, 0xffff
    v_mov_b32 v12, 0xffff0000
    v_cndmask_b32 v11, v11, v12, vcc
    v_bfe_u32 v10, v0, 1, 3
    v_cmp_eq_u32 vcc, 0, v10
    s_nop 1
    v_cndmask_b32 v6, 0, v11, vcc
    v_cmp_eq_u32 vcc, 1, v10
    s_nop 1
    v_cndmask_b32 v7, 0, v11, vcc
    v_cmp_eq_u32 vcc, 2, v10
    s_nop 1
    v_cndmask_b32 v8, 0, v11, vcc
    v_cmp_eq_u32 vcc, 3, v10
    s_nop 1
    v_cndmask_b32 v9, 0, v11, vcc
    v_mov_b32 v10, 0
    v_mov_b32 v11, 0
    v_mov_b32 v12, 0
    v_mov_b32 v13, 0
    ds_write_b128 v10, v[10:13] offset:6272
    v_and_b32 v12, 15, v0
    v_lshrrev_b32 v13, 4, v0
    v_lshlrev_b32 v12, 5, v12
    v_lshl_add_u32 v12, v13, 4, v12
    s_lshl_b32 s59, s6, 9
    s_add_u32 s59, s59, 294912
    s_lshl_b32 s61, s7, 12
    s_add_u32 s61, s61, 294912
    v_add_u32 v14, s61, v1
    v_and_b32 v10, 31, v0
    v_lshrrev_b32 v11, 5, v0
    v_lshlrev_b32 v10, 3, v10
    v_lshl_add_u32 v13, v11, 2, v10
    s_mov_b32 s44, 0x7060500
    s_mov_b32 s45, 0x7060501
    s_mov_b32 s46, 0x7060502
    s_mov_b32 s47, 0x7060503
    s_mov_b32 s49, 0x0c0c0400
    s_mov_b32 s50, 0x04000c0c
    s_waitcnt vmcnt(23)
    v_lshlrev_b32 v16, 16, v2
    v_and_b32 v17, 0xffff0000, v2
    v_lshlrev_b32 v18, 16, v3
    v_and_b32 v19, 0xffff0000, v3
    v_lshlrev_b32 v20, 16, v4
    v_and_b32 v21, 0xffff0000, v4
    v_lshlrev_b32 v22, 16, v5
    v_and_b32 v23, 0xffff0000, v5
    v_add_f32 v24, v16, v17
    v_add_f32 v25, v18, v19
    v_add_f32 v26, v20, v21
    v_add_f32 v27, v22, v23
    v_add_f32 v24, v24, v25
    v_add_f32 v26, v26, v27
    v_add_f32 v24, v24, v26
    v_mov_b32 v27, 0x3b000000
    s_nop 0
    v_add_f32_dpp v24, v24, v24 row_ror:8 row_mask:0xf bank_mask:0xf
    s_nop 1
    v_add_f32_dpp v24, v24, v24 row_ror:4 row_mask:0xf bank_mask:0xf
    s_nop 1
    v_add_f32_dpp v24, v24, v24 row_ror:2 row_mask:0xf bank_mask:0xf
    s_nop 1
    v_add_f32_dpp v24, v24, v24 row_ror:1 row_mask:0xf bank_mask:0xf
    s_nop 1
    v_add_f32_dpp v24, v24, v24 row_bcast:15 row_mask:0xa bank_mask:0xf
    s_nop 1
    v_add_f32_dpp v24, v24, v24 row_bcast:31 row_mask:0xc bank_mask:0xf
    s_nop 0
    v_readlane_b32 s62, v24, 63
    s_nop 1
    v_mul_f32 v25, s62, v27
    v_sub_f32 v26, v16, v25
    v_mul_f32 v24, v26, v26
    v_sub_f32 v26, v17, v25
    v_fmac_f32 v24, v26, v26
    v_sub_f32 v26, v18, v25
    v_fmac_f32 v24, v26, v26
    v_sub_f32 v26, v19, v25
    v_fmac_f32 v24, v26, v26
    v_sub_f32 v26, v20, v25
    v_fmac_f32 v24, v26, v26
    v_sub_f32 v26, v21, v25
    v_fmac_f32 v24, v26, v26
    v_sub_f32 v26, v22, v25
    v_fmac_f32 v24, v26, v26
    v_sub_f32 v26, v23, v25
    v_fmac_f32 v24, v26, v26
    v_cvt_pk_bf16_f32 v25, 0, v25
    v_sub_f32 v16, v16, v25
    v_sub_f32 v17, v17, v25
    v_add_f32_dpp v24, v24, v24 row_ror:8 row_mask:0xf bank_mask:0xf
    v_sub_f32 v18, v18, v25
    v_sub_f32 v19, v19, v25
    v_add_f32_dpp v24, v24, v24 row_ror:4 row_mask:0xf bank_mask:0xf
    v_sub_f32 v20, v20, v25
    v_sub_f32 v21, v21, v25
    v_add_f32_dpp v24, v24, v24 row_ror:2 row_mask:0xf bank_mask:0xf
    v_sub_f32 v22, v22, v25
    v_sub_f32 v23, v23, v25
    v_add_f32_dpp v24, v24, v24 row_ror:1 row_mask:0xf bank_mask:0xf
    v_cvt_pk_bf16_f32 v16, 0, v16
    v_cvt_pk_bf16_f32 v17, 0, v17
    v_add_f32_dpp v24, v24, v24 row_bcast:15 row_mask:0xa bank_mask:0xf
    v_cvt_pk_bf16_f32 v18, 0, v18
    v_cvt_pk_bf16_f32 v19, 0, v19
    v_add_f32_dpp v24, v24, v24 row_bcast:31 row_mask:0xc bank_mask:0xf
    s_nop 0
    v_readlane_b32 s62, v24, 63
    s_nop 1
    v_mul_f32 v24, s62, v27
    v_cvt_pk_bf16_f32 v24, 0, v24
    v_add_f32 v24, 0x3727c5ac, v24
    v_cvt_pk_bf16_f32 v24, 0, v24
    v_sqrt_f32 v24, v24
    s_nop 0
    v_cvt_pk_bf16_f32 v24, 0, v24
    v_rcp_f32 v24, v24
    v_cvt_pk_bf16_f32 v20, 0, v20
    v_cvt_pk_bf16_f32 v21, 0, v21
    v_cvt_pk_bf16_f32 v22, 0, v22
    v_cvt_pk_bf16_f32 v23, 0, v23
    v_mul_f32 v16, v16, v24
    v_mul_f32 v17, v17, v24
    v_mul_f32 v18, v18, v24
    v_mul_f32 v19, v19, v24
    v_mul_f32 v20, v20, v24
    v_mul_f32 v21, v21, v24
    v_mul_f32 v22, v22, v24
    v_mul_f32 v23, v23, v24
    v_cvt_pk_bf16_f32 v16, v16, v16
    v_cvt_pk_bf16_f32 v17, v17, v17
    v_cvt_pk_bf16_f32 v18, v18, v18
    v_cvt_pk_bf16_f32 v19, v19, v19
    v_cvt_pk_bf16_f32 v20, v20, v20
    v_cvt_pk_bf16_f32 v21, v21, v21
    v_cvt_pk_bf16_f32 v22, v22, v22
    v_cvt_pk_bf16_f32 v23, v23, v23
    v_lshlrev_b32 v1, 5, v0
    ds_write_b128 v1, v[16:19] offset:0
    ds_write_b128 v1, v[20:23] offset:16
    s_waitcnt lgkmcnt(0)
    s_add_u32 s48, s43, 1
    v_mov_b32 v1, s48
    ds_read_b128 v[96:99], v15 offset:0
    ds_read_b128 v[100:103], v15 offset:64
    ds_read_b128 v[104:107], v15 offset:128
    ds_read_b128 v[108:111], v15 offset:192
    s_waitcnt lgkmcnt(3)
    v_and_b32 v16, v96, v6
    v_and_b32 v17, v96, v7
    v_and_b32 v18, v96, v8
    v_and_b32 v19, v96, v9
    s_waitcnt vmcnt(22)
    s_nop 0
    v_mfma_f32_16x16x32_bf16 v[2:5], v[16:19], v[28:31], 0
    v_and_b32 v20, v97, v6
    v_and_b32 v21, v97, v7
    v_and_b32 v22, v97, v8
    v_and_b32 v23, v97, v9
    s_waitcnt vmcnt(21)
    s_nop 0
    v_mfma_f32_16x16x32_bf16 v[2:5], v[20:23], v[32:35], v[2:5]
    v_and_b32 v16, v98, v6
    v_and_b32 v17, v98, v7
    v_and_b32 v18, v98, v8
    v_and_b32 v19, v98, v9
    s_waitcnt vmcnt(20)
    s_nop 0
    v_mfma_f32_16x16x32_bf16 v[2:5], v[16:19], v[36:39], v[2:5]
    v_and_b32 v20, v99, v6
    v_and_b32 v21, v99, v7
    v_and_b32 v22, v99, v8
    v_and_b32 v23, v99, v9
    s_waitcnt vmcnt(19)
    s_nop 0
    v_mfma_f32_16x16x32_bf16 v[2:5], v[20:23], v[40:43], v[2:5]
    s_waitcnt lgkmcnt(2)
    v_and_b32 v16, v100, v6
    v_and_b32 v17, v100, v7
    v_and_b32 v18, v100, v8
    v_and_b32 v19, v100, v9
    s_waitcnt vmcnt(18)
    s_nop 0
    v_mfma_f32_16x16x32_bf16 v[2:5], v[16:19], v[44:47], v[2:5]
    v_and_b32 v20, v101, v6
    v_and_b32 v21, v101, v7
    v_and_b32 v22, v101, v8
    v_and_b32 v23, v101, v9
    s_waitcnt vmcnt(17)
    s_nop 0
    v_mfma_f32_16x16x32_bf16 v[2:5], v[20:23], v[48:51], v[2:5]
    v_and_b32 v16, v102, v6
    v_and_b32 v17, v102, v7
    v_and_b32 v18, v102, v8
    v_and_b32 v19, v102, v9
    s_waitcnt vmcnt(16)
    s_nop 0
    v_mfma_f32_16x16x32_bf16 v[2:5], v[16:19], v[52:55], v[2:5]
    v_and_b32 v20, v103, v6
    v_and_b32 v21, v103, v7
    v_and_b32 v22, v103, v8
    v_and_b32 v23, v103, v9
    s_waitcnt vmcnt(15)
    s_nop 0
    v_mfma_f32_16x16x32_bf16 v[2:5], v[20:23], v[56:59], v[2:5]
    s_waitcnt lgkmcnt(1)
    v_and_b32 v16, v104, v6
    v_and_b32 v17, v104, v7
    v_and_b32 v18, v104, v8
    v_and_b32 v19, v104, v9
    s_waitcnt vmcnt(14)
    s_nop 0
    v_mfma_f32_16x16x32_bf16 v[2:5], v[16:19], v[60:63], v[2:5]
    v_and_b32 v20, v105, v6
    v_and_b32 v21, v105, v7
    v_and_b32 v22, v105, v8
    v_and_b32 v23, v105, v9
    s_waitcnt vmcnt(13)
    s_nop 0
    v_mfma_f32_16x16x32_bf16 v[2:5], v[20:23], v[64:67], v[2:5]
    v_and_b32 v16, v106, v6
    v_and_b32 v17, v106, v7
    v_and_b32 v18, v106, v8
    v_and_b32 v19, v106, v9
    s_waitcnt vmcnt(12)
    s_nop 0
    v_mfma_f32_16x16x32_bf16 v[2:5], v[16:19], v[68:71], v[2:5]
    v_and_b32 v20, v107, v6
    v_and_b32 v21, v107, v7
    v_and_b32 v22, v107, v8
    v_and_b32 v23, v107, v9
    s_waitcnt vmcnt(11)
    s_nop 0
    v_mfma_f32_16x16x32_bf16 v[2:5], v[20:23], v[72:75], v[2:5]
    s_waitcnt lgkmcnt(0)
    v_and_b32 v16, v108, v6
    v_and_b32 v17, v108, v7
    v_and_b32 v18, v108, v8
    v_and_b32 v19, v108, v9
    s_waitcnt vmcnt(10)
    s_nop 0
    v_mfma_f32_16x16x32_bf16 v[2:5], v[16:19], v[76:79], v[2:5]
    v_and_b32 v20, v109, v6
    v_and_b32 v21, v109, v7
    v_and_b32 v22, v109, v8
    v_and_b32 v23, v109, v9
    s_waitcnt vmcnt(9)
    s_nop 0
    v_mfma_f32_16x16x32_bf16 v[2:5], v[20:23], v[80:83], v[2:5]
    v_and_b32 v16, v110, v6
    v_and_b32 v17, v110, v7
    v_and_b32 v18, v110, v8
    v_and_b32 v19, v110, v9
    s_waitcnt vmcnt(8)
    s_nop 0
    v_mfma_f32_16x16x32_bf16 v[2:5], v[16:19], v[84:87], v[2:5]
    v_and_b32 v20, v111, v6
    v_and_b32 v21, v111, v7
    v_and_b32 v22, v111, v8
    v_and_b32 v23, v111, v9
    s_waitcnt vmcnt(7)
    s_nop 0
    v_mfma_f32_16x16x32_bf16 v[2:5], v[20:23], v[88:91], v[2:5]
    s_nop 7
    v_perm_b32 v2, v2, v1, s44
    v_perm_b32 v3, v3, v1, s45
    v_perm_b32 v4, v4, v1, s46
    v_perm_b32 v5, v5, v1, s47
    s_mov_b32 exec_hi, 0
    s_waitcnt vmcnt(0)
    buffer_store_dwordx4 v[2:5], v12, s[36:39], s59 offen sc1
    s_mov_b64 exec, -1
    s_sleep 16
    buffer_load_dwordx4 v[16:19], v14, s[36:39], 0 offen offset:0 sc1
    buffer_load_dwordx4 v[20:23], v14, s[36:39], 0 offen offset:1024 sc1
    buffer_load_dwordx4 v[24:27], v14, s[36:39], 0 offen offset:2048 sc1
    buffer_load_dwordx4 v[28:31], v14, s[36:39], 0 offen offset:3072 sc1
    s_branch L_pq_w
L_pq:
    s_mov_b64 exec, s[64:65]
    buffer_load_dwordx4 v[16:19], v14, s[36:39], 0 offen offset:0 sc1
    s_mov_b64 exec, s[66:67]
    buffer_load_dwordx4 v[20:23], v14, s[36:39], 0 offen offset:1024 sc1
    s_mov_b64 exec, s[68:69]
    buffer_load_dwordx4 v[24:27], v14, s[36:39], 0 offen offset:2048 sc1
    s_mov_b64 exec, s[70:71]
    buffer_load_dwordx4 v[28:31], v14, s[36:39], 0 offen offset:3072 sc1
    s_mov_b64 exec, -1
L_pq_w:
    s_waitcnt vmcnt(3)
    v_perm_b32 v32, v17, v16, s49
    v_perm_b32 v34, v19, v18, s50
    v_or_b32 v32, v32, v34
    v_cmp_ne_u32 s[64:65], s48, v32
    s_waitcnt vmcnt(2)
    v_perm_b32 v33, v21, v20, s49
    v_perm_b32 v34, v23, v22, s50
    v_or_b32 v33, v33, v34
    v_cmp_ne_u32 s[66:67], s48, v33
    s_mov_b64 vcc, s[64:65]
    s_waitcnt vmcnt(1)
    v_perm_b32 v32, v25, v24, s49
    v_perm_b32 v34, v27, v26, s50
    v_or_b32 v32, v32, v34
    v_cmp_ne_u32 s[68:69], s48, v32
    s_or_b64 vcc, vcc, s[66:67]
    s_waitcnt vmcnt(0)
    v_perm_b32 v33, v29, v28, s49
    v_perm_b32 v34, v31, v30, s50
    v_or_b32 v33, v33, v34
    v_cmp_ne_u32 s[70:71], s48, v33
    s_or_b64 vcc, vcc, s[68:69]
    s_or_b64 vcc, vcc, s[70:71]
    s_cbranch_scc0 L_pq_ok
    s_sub_u32 s63, s63, 1
    s_cbranch_scc0 L_pq
L_pq_ok:
    v_and_b32 v16, 0xffffff00, v16
    v_and_b32 v17, 0xffffff00, v17
    v_and_b32 v18, 0xffffff00, v18
    v_and_b32 v19, 0xffffff00, v19
    v_and_b32 v20, 0xffffff00, v20
    v_and_b32 v21, 0xffffff00, v21
    v_and_b32 v22, 0xffffff00, v22
    v_and_b32 v23, 0xffffff00, v23
    v_and_b32 v24, 0xffffff00, v24
    v_and_b32 v25, 0xffffff00, v25
    v_and_b32 v26, 0xffffff00, v26
    v_and_b32 v27, 0xffffff00, v27
    v_and_b32 v28, 0xffffff00, v28
    v_and_b32 v29, 0xffffff00, v29
    v_and_b32 v30, 0xffffff00, v30
    v_and_b32 v31, 0xffffff00, v31
    v_add_f32 v16, v16, v24
    v_add_f32 v17, v17, v25
    v_add_f32 v18, v18, v26
    v_add_f32 v19, v19, v27
    v_add_f32 v20, v20, v28
    v_add_f32 v21, v21, v29
    v_add_f32 v22, v22, v30
    v_add_f32 v23, v23, v31
    v_add_f32 v16, v16, v20
    v_add_f32 v17, v17, v21
    v_add_f32 v18, v18, v22
    v_add_f32 v19, v19, v23
    s_nop 0
    v_permlane32_swap_b32 v16, v18
    v_permlane32_swap_b32 v17, v19
    v_add_f32 v16, v16, v18
    v_add_f32 v17, v17, v19
    v_cvt_pk_bf16_f32 v16, v16, v17
    ds_write_b32 v13, v16 offset:2048
    s_waitcnt lgkmcnt(0)
L_qdone:
    s_barrier
    s_waitcnt lgkmcnt(0)
    s_add_u32 s57, s43, 1
    s_mov_b32 s50, s56
    v_mov_b32 v4, 0
    v_mov_b32 v5, 0
    v_mov_b32 v15, 0
    v_mov_b32 v46, 0
    v_mov_b32 v47, 0
    v_mov_b32 v18, 1
    v_mov_b32 v10, 0
    v_lshlrev_b32 v11, 3, v0
    v_lshlrev_b32 v12, 2, v0
    s_lshl_b32 s61, s58, 14
    s_add_u32 s52, s52, s61
    v_lshrrev_b32 v13, 3, v0
    v_and_b32 v14, 7, v0
    v_lshlrev_b32 v19, 12, v13
    v_lshl_add_u32 v19, v14, 4, v19
    s_lshl_b32 s59, s7, 17
    s_lshl_b32 s61, s58, 15
    s_add_u32 s59, s59, s61
    s_and_b32 s61, s5, 7
    s_lshl_b32 s61, s61, 7
    s_add_u32 s59, s59, s61
    buffer_load_dwordx4 v[48:51], v19, s[16:19], s59 offen offset:0 nt
    buffer_load_dwordx4 v[52:55], v19, s[16:19], s59 offen offset:1024 nt
    buffer_load_dwordx4 v[56:59], v19, s[16:19], s59 offen offset:2048 nt
    buffer_load_dwordx4 v[60:63], v19, s[16:19], s59 offen offset:3072 nt
    v_and_b32 v19, 1, v0
    v_cmp_eq_u32 vcc, 1, v19
    v_mov_b32 v20, 0xffff
    v_mov_b32 v21, 0xffff0000
    v_cndmask_b32 v20, v20, v21, vcc
    v_bfe_u32 v19, v0, 1, 2
    v_cmp_eq_u32 vcc, 0, v19
    s_nop 1
    v_cndmask_b32 v6, 0, v20, vcc
    v_cmp_eq_u32 vcc, 1, v19
    s_nop 1
    v_cndmask_b32 v7, 0, v20, vcc
    v_cmp_eq_u32 vcc, 2, v19
    s_nop 1
    v_cndmask_b32 v8, 0, v20, vcc
    v_cmp_eq_u32 vcc, 3, v19
    s_nop 1
    v_cndmask_b32 v9, 0, v20, vcc
    v_lshlrev_b32 v1, 9, v14
    v_lshl_add_u32 v1, v13, 4, v1
    s_lshl_b32 s59, s7, 12
    s_lshl_b32 s61, s58, 7
    s_add_u32 s59, s59, s61
    v_add_u32 v1, s59, v1
    v_lshlrev_b32 v2, 7, v14
    s_lshl_b32 s59, s7, 10
    s_add_u32 s59, s59, 131072
    v_add_u32 v2, s59, v2
    v_lshrrev_b32 v19, 5, v0
    v_lshlrev_b32 v3, 8, v19
    v_lshl_add_u32 v3, v14, 5, v3
    v_bfe_u32 v19, v0, 4, 1
    v_lshl_add_u32 v3, v19, 4, v3
    s_lshl_b32 s59, s58, 9
    v_add_u32 v3, s59, v3
    s_cmp_lt_u32 s50, 28
    s_cbranch_scc1 L_ffn_init
    s_sub_u32 s51, s50, 32
    s_cmp_ge_u32 s51, 16
    s_cbranch_scc1 L_init_done
    v_lshlrev_b32 v4, 9, v13
    v_lshl_add_u32 v4, v14, 4, v4
    s_lshr_b32 s59, s51, 2
    s_lshl_b32 s59, s59, 14
    s_and_b32 s61, s51, 3
    s_lshl_b32 s61, s61, 7
    s_add_u32 s59, s59, s61
    v_add_u32 v4, s59, v4
    v_add_u32 v5, 229376, v4
    v_add_u32 v4, 163840, v4
    v_lshrrev_b32 v19, 5, v0
    v_lshl_add_u32 v46, v19, 30, v5
    v_lshrrev_b32 v19, 4, v0
    v_lshl_add_u32 v15, v14, 2, v19
    v_lshlrev_b32 v15, 1, v15
    s_lshl_b32 s59, s51, 6
    v_add_u32 v15, s59, v15
    buffer_load_ushort v13, v15, s[8:11], 0 offen
    s_waitcnt vmcnt(0)
    v_lshlrev_b32 v13, 16, v13
    s_branch L_init_done
L_ffn_init:
    s_movk_i32 s59, 3584
    v_mul_lo_u32 v19, v13, s59
    v_lshl_add_u32 v19, v14, 4, v19
    s_mul_i32 s59, s58, 458752
    s_lshl_b32 s61, s50, 7
    s_add_u32 s59, s59, s61
    s_lshl_b32 s43, s58, 14
    s_add_u32 m0, s43, 12288
    s_add_u32 s61, s59, 0
    buffer_load_dwordx4 v19, s[20:23], s61 offen nt lds
    s_add_u32 m0, s43, 13312
    s_add_u32 s61, s59, 28672
    buffer_load_dwordx4 v19, s[20:23], s61 offen nt lds
    s_add_u32 m0, s43, 14336
    s_add_u32 s61, s59, 57344
    buffer_load_dwordx4 v19, s[20:23], s61 offen nt lds
    s_add_u32 m0, s43, 15360
    s_add_u32 s61, s59, 86016
    buffer_load_dwordx4 v19, s[20:23], s61 offen nt lds
    s_add_u32 m0, s43, 16384
    s_add_u32 s61, s59, 114688
    buffer_load_dwordx4 v19, s[20:23], s61 offen nt lds
    s_waitcnt vmcnt(4)
    s_add_u32 m0, s43, 17408
    s_add_u32 s61, s59, 143360
    buffer_load_dwordx4 v19, s[20:23], s61 offen nt lds
    s_waitcnt vmcnt(4)
    s_add_u32 m0, s43, 18432
    s_add_u32 s61, s59, 172032
    buffer_load_dwordx4 v19, s[20:23], s61 offen nt lds
    s_waitcnt vmcnt(4)
    s_add_u32 m0, s43, 19456
    s_add_u32 s61, s59, 200704
    buffer_load_dwordx4 v19, s[20:23], s61 offen nt lds
    s_waitcnt vmcnt(4)
    s_add_u32 m0, s43, 20480
    s_add_u32 s61, s59, 229376
    buffer_load_dwordx4 v19, s[20:23], s61 offen nt lds
    s_waitcnt vmcnt(4)
    s_add_u32 m0, s43, 21504
    s_add_u32 s61, s59, 258048
    buffer_load_dwordx4 v19, s[20:23], s61 offen nt lds
    s_waitcnt vmcnt(4)
    s_add_u32 m0, s43, 22528
    s_add_u32 s61, s59, 286720
    buffer_load_dwordx4 v19, s[20:23], s61 offen nt lds
    s_waitcnt vmcnt(4)
    s_add_u32 m0, s43, 23552
    s_add_u32 s61, s59, 315392
    buffer_load_dwordx4 v19, s[20:23], s61 offen nt lds
    s_waitcnt vmcnt(4)
    s_add_u32 m0, s43, 24576
    s_add_u32 s61, s59, 344064
    buffer_load_dwordx4 v19, s[20:23], s61 offen nt lds
    s_waitcnt vmcnt(4)
    s_add_u32 m0, s43, 25600
    s_add_u32 s61, s59, 372736
    buffer_load_dwordx4 v19, s[20:23], s61 offen nt lds
    s_waitcnt vmcnt(4)
    s_add_u32 m0, s43, 26624
    s_add_u32 s61, s59, 401408
    buffer_load_dwordx4 v19, s[20:23], s61 offen nt lds
    s_waitcnt vmcnt(4)
    s_add_u32 m0, s43, 27648
    s_add_u32 s61, s59, 430080
    buffer_load_dwordx4 v19, s[20:23], s61 offen nt lds
    s_waitcnt vmcnt(4)
    v_lshrrev_b32 v15, 4, v0
    v_and_b32 v20, 15, v0
    v_lshlrev_b32 v19, 10, v15
    v_lshl_add_u32 v19, v20, 4, v19
    s_lshl_b32 s59, s50, 16
    s_lshl_b32 s61, s58, 8
    s_add_u32 s59, s59, s61
    s_add_u32 m0, s43, 77824
    s_add_u32 s61, s59, 0
    buffer_load_dwordx4 v19, s[24:27], s61 offen nt lds
    s_waitcnt vmcnt(4)
    s_add_u32 m0, s43, 78848
    s_add_u32 s61, s59, 4096
    buffer_load_dwordx4 v19, s[24:27], s61 offen nt lds
    s_waitcnt vmcnt(4)
    s_add_u32 m0, s43, 79872
    s_add_u32 s61, s59, 8192
    buffer_load_dwordx4 v19, s[24:27], s61 offen nt lds
    s_waitcnt vmcnt(4)
    s_add_u32 m0, s43, 80896
    s_add_u32 s61, s59, 12288
    buffer_load_dwordx4 v19, s[24:27], s61 offen nt lds
    s_waitcnt vmcnt(4)
    s_add_u32 m0, s43, 81920
    s_add_u32 s61, s59, 16384
    buffer_load_dwordx4 v19, s[24:27], s61 offen nt lds
    s_waitcnt vmcnt(4)
    s_add_u32 m0, s43, 82944
    s_add_u32 s61, s59, 20480
    buffer_load_dwordx4 v19, s[24:27], s61 offen nt lds
    s_waitcnt vmcnt(4)
    s_add_u32 m0, s43, 83968
    s_add_u32 s61, s59, 24576
    buffer_load_dwordx4 v19, s[24:27], s61 offen nt lds
    s_waitcnt vmcnt(4)
    s_add_u32 m0, s43, 84992
    s_add_u32 s61, s59, 28672
    buffer_load_dwordx4 v19, s[24:27], s61 offen nt lds
    s_waitcnt vmcnt(4)
    s_add_u32 m0, s43, 86016
    s_add_u32 s61, s59, 32768
    buffer_load_dwordx4 v19, s[24:27], s61 offen nt lds
    s_waitcnt vmcnt(4)
    s_add_u32 m0, s43, 87040
    s_add_u32 s61, s59, 36864
    buffer_load_dwordx4 v19, s[24:27], s61 offen nt lds
    s_waitcnt vmcnt(4)
    s_add_u32 m0, s43, 88064
    s_add_u32 s61, s59, 40960
    buffer_load_dwordx4 v19, s[24:27], s61 offen nt lds
    s_waitcnt vmcnt(4)
    s_add_u32 m0, s43, 89088
    s_add_u32 s61, s59, 45056
    buffer_load_dwordx4 v19, s[24:27], s61 offen nt lds
    s_waitcnt vmcnt(4)
    s_add_u32 m0, s43, 90112
    s_add_u32 s61, s59, 49152
    buffer_load_dwordx4 v19, s[24:27], s61 offen nt lds
    s_waitcnt vmcnt(4)
    s_add_u32 m0, s43, 91136
    s_add_u32 s61, s59, 53248
    buffer_load_dwordx4 v19, s[24:27], s61 offen nt lds
    s_waitcnt vmcnt(4)
    s_add_u32 m0, s43, 92160
    s_add_u32 s61, s59, 57344
    buffer_load_dwordx4 v19, s[24:27], s61 offen nt lds
    s_waitcnt vmcnt(4)
    s_add_u32 m0, s43, 93184
    s_add_u32 s61, s59, 61440
    buffer_load_dwordx4 v19, s[24:27], s61 offen nt lds
    s_waitcnt vmcnt(4)
    v_and_b32 v21, 31, v0
    v_lshrrev_b32 v22, 5, v0
    s_lshl_b32 s59, s58, 8
    v_lshlrev_b32 v5, 3, v21
    v_lshl_add_u32 v5, v22, 2, v5
    v_add_u32 v5, s59, v5
    buffer_load_dword v14, v5, s[8:11], 0 offen
    v_lshlrev_b32 v47, 4, v0
    s_add_u32 s59, s43, 163840
    v_add_u32 v4, s59, v47
    v_lshlrev_b32 v21, 11, v15
    v_lshl_add_u32 v21, v20, 2, v21
    s_add_u32 s59, s43, 77824
    v_add_u32 v21, s59, v21
    v_lshlrev_b32 v19, 10, v15
    v_lshl_add_u32 v19, v20, 1, v19
    s_lshl_b32 s59, s58, 5
    v_add_u32 v19, s59, v19
    v_lshl_add_u32 v46, v20, 1, s59
    v_lshlrev_b32 v15, 4, v15
    s_waitcnt vmcnt(0)
    s_mov_b64 exec, 1
    ds_add_u32 v10, v18 offset:6280
    s_mov_b64 exec, -1
    v_lshlrev_b32 v13, 16, v14
    v_and_b32 v14, 0xffff0000, v14
    ds_read_u16 v24, v21 offset:0
    ds_read_u16 v25, v21 offset:256
    ds_read_u16 v26, v21 offset:512
    ds_read_u16 v27, v21 offset:768
    ds_read_u16 v28, v21 offset:1024
    ds_read_u16 v29, v21 offset:1280
    ds_read_u16 v30, v21 offset:1536
    ds_read_u16 v31, v21 offset:1792
    s_waitcnt lgkmcnt(0)
    v_lshl_or_b32 v128, v25, 16, v24
    v_lshl_or_b32 v129, v27, 16, v26
    v_lshl_or_b32 v130, v29, 16, v28
    v_lshl_or_b32 v131, v31, 16, v30
    ds_read_u16 v24, v21 offset:8192
    ds_read_u16 v25, v21 offset:8448
    ds_read_u16 v26, v21 offset:8704
    ds_read_u16 v27, v21 offset:8960
    ds_read_u16 v28, v21 offset:9216
    ds_read_u16 v29, v21 offset:9472
    ds_read_u16 v30, v21 offset:9728
    ds_read_u16 v31, v21 offset:9984
    s_waitcnt lgkmcnt(0)
    v_lshl_or_b32 v132, v25, 16, v24
    v_lshl_or_b32 v133, v27, 16, v26
    v_lshl_or_b32 v134, v29, 16, v28
    v_lshl_or_b32 v135, v31, 16, v30
    ds_read_u16 v24, v21 offset:2
    ds_read_u16 v25, v21 offset:258
    ds_read_u16 v26, v21 offset:514
    ds_read_u16 v27, v21 offset:770
    ds_read_u16 v28, v21 offset:1026
    ds_read_u16 v29, v21 offset:1282
    ds_read_u16 v30, v21 offset:1538
    ds_read_u16 v31, v21 offset:1794
    s_waitcnt lgkmcnt(0)
    v_lshl_or_b32 v136, v25, 16, v24
    v_lshl_or_b32 v137, v27, 16, v26
    v_lshl_or_b32 v138, v29, 16, v28
    v_lshl_or_b32 v139, v31, 16, v30
    ds_read_u16 v24, v21 offset:8194
    ds_read_u16 v25, v21 offset:8450
    ds_read_u16 v26, v21 offset:8706
    ds_read_u16 v27, v21 offset:8962
    ds_read_u16 v28, v21 offset:9218
    ds_read_u16 v29, v21 offset:9474
    ds_read_u16 v30, v21 offset:9730
    ds_read_u16 v31, v21 offset:9986
    s_waitcnt lgkmcnt(0)
    v_lshl_or_b32 v140, v25, 16, v24
    v_lshl_or_b32 v141, v27, 16, v26
    v_lshl_or_b32 v142, v29, 16, v28
    v_lshl_or_b32 v143, v31, 16, v30
    ds_read_u16 v24, v21 offset:64
    ds_read_u16 v25, v21 offset:320
    ds_read_u16 v26, v21 offset:576
    ds_read_u16 v27, v21 offset:832
    ds_read_u16 v28, v21 offset:1088
    ds_read_u16 v29, v21 offset:1344
    ds_read_u16 v30, v21 offset:1600
    ds_read_u16 v31, v21 offset:1856
    s_waitcnt lgkmcnt(0)
    v_lshl_or_b32 v144, v25, 16, v24
    v_lshl_or_b32 v145, v27, 16, v26
    v_lshl_or_b32 v146, v29, 16, v28
    v_lshl_or_b32 v147, v31, 16, v30
    ds_read_u16 v24, v21 offset:8256
    ds_read_u16 v25, v21 offset:8512
    ds_read_u16 v26, v21 offset:8768
    ds_read_u16 v27, v21 offset:9024
    ds_read_u16 v28, v21 offset:9280
    ds_read_u16 v29, v21 offset:9536
    ds_read_u16 v30, v21 offset:9792
    ds_read_u16 v31, v21 offset:10048
    s_waitcnt lgkmcnt(0)
    v_lshl_or_b32 v148, v25, 16, v24
    v_lshl_or_b32 v149, v27, 16, v26
    v_lshl_or_b32 v150, v29, 16, v28
    v_lshl_or_b32 v151, v31, 16, v30
    ds_read_u16 v24, v21 offset:66
    ds_read_u16 v25, v21 offset:322
    ds_read_u16 v26, v21 offset:578
    ds_read_u16 v27, v21 offset:834
    ds_read_u16 v28, v21 offset:1090
    ds_read_u16 v29, v21 offset:1346
    ds_read_u16 v30, v21 offset:1602
    ds_read_u16 v31, v21 offset:1858
    s_waitcnt lgkmcnt(0)
    v_lshl_or_b32 v152, v25, 16, v24
    v_lshl_or_b32 v153, v27, 16, v26
    v_lshl_or_b32 v154, v29, 16, v28
    v_lshl_or_b32 v155, v31, 16, v30
    ds_read_u16 v24, v21 offset:8258
    ds_read_u16 v25, v21 offset:8514
    ds_read_u16 v26, v21 offset:8770
    ds_read_u16 v27, v21 offset:9026
    ds_read_u16 v28, v21 offset:9282
    ds_read_u16 v29, v21 offset:9538
    ds_read_u16 v30, v21 offset:9794
    ds_read_u16 v31, v21 offset:10050
    s_waitcnt lgkmcnt(0)
    v_lshl_or_b32 v156, v25, 16, v24
    v_lshl_or_b32 v157, v27, 16, v26
    v_lshl_or_b32 v158, v29, 16, v28
    v_lshl_or_b32 v159, v31, 16, v30
    ds_read_u16 v24, v21 offset:128
    ds_read_u16 v25, v21 offset:384
    ds_read_u16 v26, v21 offset:640
    ds_read_u16 v27, v21 offset:896
    ds_read_u16 v28, v21 offset:1152
    ds_read_u16 v29, v21 offset:1408
    ds_read_u16 v30, v21 offset:1664
    ds_read_u16 v31, v21 offset:1920
    s_waitcnt lgkmcnt(0)
    v_lshl_or_b32 v160, v25, 16, v24
    v_lshl_or_b32 v161, v27, 16, v26
    v_lshl_or_b32 v162, v29, 16, v28
    v_lshl_or_b32 v163, v31, 16, v30
    ds_read_u16 v24, v21 offset:8320
    ds_read_u16 v25, v21 offset:8576
    ds_read_u16 v26, v21 offset:8832
    ds_read_u16 v27, v21 offset:9088
    ds_read_u16 v28, v21 offset:9344
    ds_read_u16 v29, v21 offset:9600
    ds_read_u16 v30, v21 offset:9856
    ds_read_u16 v31, v21 offset:10112
    s_waitcnt lgkmcnt(0)
    v_lshl_or_b32 v164, v25, 16, v24
    v_lshl_or_b32 v165, v27, 16, v26
    v_lshl_or_b32 v166, v29, 16, v28
    v_lshl_or_b32 v167, v31, 16, v30
    ds_read_u16 v24, v21 offset:130
    ds_read_u16 v25, v21 offset:386
    ds_read_u16 v26, v21 offset:642
    ds_read_u16 v27, v21 offset:898
    ds_read_u16 v28, v21 offset:1154
    ds_read_u16 v29, v21 offset:1410
    ds_read_u16 v30, v21 offset:1666
    ds_read_u16 v31, v21 offset:1922
    s_waitcnt lgkmcnt(0)
    v_lshl_or_b32 v168, v25, 16, v24
    v_lshl_or_b32 v169, v27, 16, v26
    v_lshl_or_b32 v170, v29, 16, v28
    v_lshl_or_b32 v171, v31, 16, v30
    ds_read_u16 v24, v21 offset:8322
    ds_read_u16 v25, v21 offset:8578
    ds_read_u16 v26, v21 offset:8834
    ds_read_u16 v27, v21 offset:9090
    ds_read_u16 v28, v21 offset:9346
    ds_read_u16 v29, v21 offset:9602
    ds_read_u16 v30, v21 offset:9858
    ds_read_u16 v31, v21 offset:10114
    s_waitcnt lgkmcnt(0)
    v_lshl_or_b32 v172, v25, 16, v24
    v_lshl_or_b32 v173, v27, 16, v26
    v_lshl_or_b32 v174, v29, 16, v28
    v_lshl_or_b32 v175, v31, 16, v30
    ds_read_u16 v24, v21 offset:192
    ds_read_u16 v25, v21 offset:448
    ds_read_u16 v26, v21 offset:704
    ds_read_u16 v27, v21 offset:960
    ds_read_u16 v28, v21 offset:1216
    ds_read_u16 v29, v21 offset:1472
    ds_read_u16 v30, v21 offset:1728
    ds_read_u16 v31, v21 offset:1984
    s_waitcnt lgkmcnt(0)
    v_lshl_or_b32 v176, v25, 16, v24
    v_lshl_or_b32 v177, v27, 16, v26
    v_lshl_or_b32 v178, v29, 16, v28
    v_lshl_or_b32 v179, v31, 16, v30
    ds_read_u16 v24, v21 offset:8384
    ds_read_u16 v25, v21 offset:8640
    ds_read_u16 v26, v21 offset:8896
    ds_read_u16 v27, v21 offset:9152
    ds_read_u16 v28, v21 offset:9408
    ds_read_u16 v29, v21 offset:9664
    ds_read_u16 v30, v21 offset:9920
    ds_read_u16 v31, v21 offset:10176
    s_waitcnt lgkmcnt(0)
    v_lshl_or_b32 v180, v25, 16, v24
    v_lshl_or_b32 v181, v27, 16, v26
    v_lshl_or_b32 v182, v29, 16, v28
    v_lshl_or_b32 v183, v31, 16, v30
    ds_read_u16 v24, v21 offset:194
    ds_read_u16 v25, v21 offset:450
    ds_read_u16 v26, v21 offset:706
    ds_read_u16 v27, v21 offset:962
    ds_read_u16 v28, v21 offset:1218
    ds_read_u16 v29, v21 offset:1474
    ds_read_u16 v30, v21 offset:1730
    ds_read_u16 v31, v21 offset:1986
    s_waitcnt lgkmcnt(0)
    v_lshl_or_b32 v184, v25, 16, v24
    v_lshl_or_b32 v185, v27, 16, v26
    v_lshl_or_b32 v186, v29, 16, v28
    v_lshl_or_b32 v187, v31, 16, v30
    ds_read_u16 v24, v21 offset:8386
    ds_read_u16 v25, v21 offset:8642
    ds_read_u16 v26, v21 offset:8898
    ds_read_u16 v27, v21 offset:9154
    ds_read_u16 v28, v21 offset:9410
    ds_read_u16 v29, v21 offset:9666
    ds_read_u16 v30, v21 offset:9922
    ds_read_u16 v31, v21 offset:10178
    s_waitcnt lgkmcnt(0)
    v_lshl_or_b32 v188, v25, 16, v24
    v_lshl_or_b32 v189, v27, 16, v26
    v_lshl_or_b32 v190, v29, 16, v28
    v_lshl_or_b32 v191, v31, 16, v30
L_w1wait:
    ds_read_b32 v24, v10 offset:6280
    s_waitcnt lgkmcnt(0)
    v_cmp_gt_u32 vcc, 4, v24
    s_cbranch_vccz L_w1ok
    s_sleep 8
    s_sub_u32 s63, s63, 1
    s_cbranch_scc0 L_w1wait
L_w1ok:
    v_add_u32 v19, 12288, v19
    ds_read_u16 v24, v19 offset:0
    ds_read_u16 v25, v19 offset:128
    ds_read_u16 v26, v19 offset:256
    ds_read_u16 v27, v19 offset:384
    ds_read_u16 v28, v19 offset:512
    ds_read_u16 v29, v19 offset:640
    ds_read_u16 v30, v19 offset:768
    ds_read_u16 v31, v19 offset:896
    s_waitcnt lgkmcnt(0)
    v_lshl_or_b32 v64, v25, 16, v24
    v_lshl_or_b32 v65, v27, 16, v26
    v_lshl_or_b32 v66, v29, 16, v28
    v_lshl_or_b32 v67, v31, 16, v30
    ds_read_u16 v24, v19 offset:4096
    ds_read_u16 v25, v19 offset:4224
    ds_read_u16 v26, v19 offset:4352
    ds_read_u16 v27, v19 offset:4480
    ds_read_u16 v28, v19 offset:4608
    ds_read_u16 v29, v19 offset:4736
    ds_read_u16 v30, v19 offset:4864
    ds_read_u16 v31, v19 offset:4992
    s_waitcnt lgkmcnt(0)
    v_lshl_or_b32 v68, v25, 16, v24
    v_lshl_or_b32 v69, v27, 16, v26
    v_lshl_or_b32 v70, v29, 16, v28
    v_lshl_or_b32 v71, v31, 16, v30
    ds_read_u16 v24, v19 offset:8192
    ds_read_u16 v25, v19 offset:8320
    ds_read_u16 v26, v19 offset:8448
    ds_read_u16 v27, v19 offset:8576
    ds_read_u16 v28, v19 offset:8704
    ds_read_u16 v29, v19 offset:8832
    ds_read_u16 v30, v19 offset:8960
    ds_read_u16 v31, v19 offset:9088
    s_waitcnt lgkmcnt(0)
    v_lshl_or_b32 v72, v25, 16, v24
    v_lshl_or_b32 v73, v27, 16, v26
    v_lshl_or_b32 v74, v29, 16, v28
    v_lshl_or_b32 v75, v31, 16, v30
    ds_read_u16 v24, v19 offset:12288
    ds_read_u16 v25, v19 offset:12416
    ds_read_u16 v26, v19 offset:12544
    ds_read_u16 v27, v19 offset:12672
    ds_read_u16 v28, v19 offset:12800
    ds_read_u16 v29, v19 offset:12928
    ds_read_u16 v30, v19 offset:13056
    ds_read_u16 v31, v19 offset:13184
    s_waitcnt lgkmcnt(0)
    v_lshl_or_b32 v76, v25, 16, v24
    v_lshl_or_b32 v77, v27, 16, v26
    v_lshl_or_b32 v78, v29, 16, v28
    v_lshl_or_b32 v79, v31, 16, v30
    ds_read_u16 v24, v19 offset:16384
    ds_read_u16 v25, v19 offset:16512
    ds_read_u16 v26, v19 offset:16640
    ds_read_u16 v27, v19 offset:16768
    ds_read_u16 v28, v19 offset:16896
    ds_read_u16 v29, v19 offset:17024
    ds_read_u16 v30, v19 offset:17152
    ds_read_u16 v31, v19 offset:17280
    s_waitcnt lgkmcnt(0)
    v_lshl_or_b32 v80, v25, 16, v24
    v_lshl_or_b32 v81, v27, 16, v26
    v_lshl_or_b32 v82, v29, 16, v28
    v_lshl_or_b32 v83, v31, 16, v30
    ds_read_u16 v24, v19 offset:20480
    ds_read_u16 v25, v19 offset:20608
    ds_read_u16 v26, v19 offset:20736
    ds_read_u16 v27, v19 offset:20864
    ds_read_u16 v28, v19 offset:20992
    ds_read_u16 v29, v19 offset:21120
    ds_read_u16 v30, v19 offset:21248
    ds_read_u16 v31, v19 offset:21376
    s_waitcnt lgkmcnt(0)
    v_lshl_or_b32 v84, v25, 16, v24
    v_lshl_or_b32 v85, v27, 16, v26
    v_lshl_or_b32 v86, v29, 16, v28
    v_lshl_or_b32 v87, v31, 16, v30
    ds_read_u16 v24, v19 offset:24576
    ds_read_u16 v25, v19 offset:24704
    ds_read_u16 v26, v19 offset:24832
    ds_read_u16 v27, v19 offset:24960
    ds_read_u16 v28, v19 offset:25088
    ds_read_u16 v29, v19 offset:25216
    ds_read_u16 v30, v19 offset:25344
    ds_read_u16 v31, v19 offset:25472
    s_waitcnt lgkmcnt(0)
    v_lshl_or_b32 v88, v25, 16, v24
    v_lshl_or_b32 v89, v27, 16, v26
    v_lshl_or_b32 v90, v29, 16, v28
    v_lshl_or_b32 v91, v31, 16, v30
    ds_read_u16 v24, v19 offset:28672
    ds_read_u16 v25, v19 offset:28800
    ds_read_u16 v26, v19 offset:28928
    ds_read_u16 v27, v19 offset:29056
    ds_read_u16 v28, v19 offset:29184
    ds_read_u16 v29, v19 offset:29312
    ds_read_u16 v30, v19 offset:29440
    ds_read_u16 v31, v19 offset:29568
    s_waitcnt lgkmcnt(0)
    v_lshl_or_b32 v92, v25, 16, v24
    v_lshl_or_b32 v93, v27, 16, v26
    v_lshl_or_b32 v94, v29, 16, v28
    v_lshl_or_b32 v95, v31, 16, v30
    ds_read_u16 v24, v19 offset:32768
    ds_read_u16 v25, v19 offset:32896
    ds_read_u16 v26, v19 offset:33024
    ds_read_u16 v27, v19 offset:33152
    ds_read_u16 v28, v19 offset:33280
    ds_read_u16 v29, v19 offset:33408
    ds_read_u16 v30, v19 offset:33536
    ds_read_u16 v31, v19 offset:33664
    s_waitcnt lgkmcnt(0)
    v_lshl_or_b32 v96, v25, 16, v24
    v_lshl_or_b32 v97, v27, 16, v26
    v_lshl_or_b32 v98, v29, 16, v28
    v_lshl_or_b32 v99, v31, 16, v30
    ds_read_u16 v24, v19 offset:36864
    ds_read_u16 v25, v19 offset:36992
    ds_read_u16 v26, v19 offset:37120
    ds_read_u16 v27, v19 offset:37248
    ds_read_u16 v28, v19 offset:37376
    ds_read_u16 v29, v19 offset:37504
    ds_read_u16 v30, v19 offset:37632
    ds_read_u16 v31, v19 offset:37760
    s_waitcnt lgkmcnt(0)
    v_lshl_or_b32 v100, v25, 16, v24
    v_lshl_or_b32 v101, v27, 16, v26
    v_lshl_or_b32 v102, v29, 16, v28
    v_lshl_or_b32 v103, v31, 16, v30
    ds_read_u16 v24, v19 offset:40960
    ds_read_u16 v25, v19 offset:41088
    ds_read_u16 v26, v19 offset:41216
    ds_read_u16 v27, v19 offset:41344
    ds_read_u16 v28, v19 offset:41472
    ds_read_u16 v29, v19 offset:41600
    ds_read_u16 v30, v19 offset:41728
    ds_read_u16 v31, v19 offset:41856
    s_waitcnt lgkmcnt(0)
    v_lshl_or_b32 v104, v25, 16, v24
    v_lshl_or_b32 v105, v27, 16, v26
    v_lshl_or_b32 v106, v29, 16, v28
    v_lshl_or_b32 v107, v31, 16, v30
    ds_read_u16 v24, v19 offset:45056
    ds_read_u16 v25, v19 offset:45184
    ds_read_u16 v26, v19 offset:45312
    ds_read_u16 v27, v19 offset:45440
    ds_read_u16 v28, v19 offset:45568
    ds_read_u16 v29, v19 offset:45696
    ds_read_u16 v30, v19 offset:45824
    ds_read_u16 v31, v19 offset:45952
    s_waitcnt lgkmcnt(0)
    v_lshl_or_b32 v108, v25, 16, v24
    v_lshl_or_b32 v109, v27, 16, v26
    v_lshl_or_b32 v110, v29, 16, v28
    v_lshl_or_b32 v111, v31, 16, v30
    ds_read_u16 v24, v19 offset:49152
    ds_read_u16 v25, v19 offset:49280
    ds_read_u16 v26, v19 offset:49408
    ds_read_u16 v27, v19 offset:49536
    ds_read_u16 v28, v19 offset:49664
    ds_read_u16 v29, v19 offset:49792
    ds_read_u16 v30, v19 offset:49920
    ds_read_u16 v31, v19 offset:50048
    s_waitcnt lgkmcnt(0)
    v_lshl_or_b32 v112, v25, 16, v24
    v_lshl_or_b32 v113, v27, 16, v26
    v_lshl_or_b32 v114, v29, 16, v28
    v_lshl_or_b32 v115, v31, 16, v30
    ds_read_u16 v24, v19 offset:53248
    ds_read_u16 v25, v19 offset:53376
    ds_read_u16 v26, v19 offset:53504
    ds_read_u16 v27, v19 offset:53632
    ds_read_u16 v28, v19 offset:53760
    ds_read_u16 v29, v19 offset:53888
    ds_read_u16 v30, v19 offset:54016
    ds_read_u16 v31, v19 offset:54144
    s_waitcnt lgkmcnt(0)
    v_lshl_or_b32 v116, v25, 16, v24
    v_lshl_or_b32 v117, v27, 16, v26
    v_lshl_or_b32 v118, v29, 16, v28
    v_lshl_or_b32 v119, v31, 16, v30
    ds_read_u16 v24, v19 offset:57344
    ds_read_u16 v25, v19 offset:57472
    ds_read_u16 v26, v19 offset:57600
    ds_read_u16 v27, v19 offset:57728
    ds_read_u16 v28, v19 offset:57856
    ds_read_u16 v29, v19 offset:57984
    ds_read_u16 v30, v19 offset:58112
    ds_read_u16 v31, v19 offset:58240
    s_waitcnt lgkmcnt(0)
    v_lshl_or_b32 v120, v25, 16, v24
    v_lshl_or_b32 v121, v27, 16, v26
    v_lshl_or_b32 v122, v29, 16, v28
    v_lshl_or_b32 v123, v31, 16, v30
    ds_read_u16 v24, v19 offset:61440
    ds_read_u16 v25, v19 offset:61568
    ds_read_u16 v26, v19 offset:61696
    ds_read_u16 v27, v19 offset:61824
    ds_read_u16 v28, v19 offset:61952
    ds_read_u16 v29, v19 offset:62080
    ds_read_u16 v30, v19 offset:62208
    ds_read_u16 v31, v19 offset:62336
    s_waitcnt lgkmcnt(0)
    v_lshl_or_b32 v124, v25, 16, v24
    v_lshl_or_b32 v125, v27, 16, v26
    v_lshl_or_b32 v126, v29, 16, v28
    v_lshl_or_b32 v127, v31, 16, v30
L_init_done:
    s_movk_i32 s59, 0x1000
    s_movk_i32 s60, 0x2000
    s_movk_i32 s61, 0x3000
    s_waitcnt vmcnt(0)
    s_mov_b32 s55, 1
    s_mov_b32 s38, 0
    s_mov_b32 s30, 0
    s_mov_b32 s34, 0
    s_branch L_tail
L_tail_done:
    s_cmp_eq_u32 s55, 0
    s_cbranch_scc1 L_hend
    s_mov_b64 exec, -1
    s_waitcnt vmcnt(0) lgkmcnt(0)
    s_mov_b32 s55, 0
    s_mov_b32 s38, 426112
    s_mov_b32 s30, 1024
    s_mov_b32 s34, 256
    s_cmp_lg_u32 s58, 0
    s_cbranch_scc1 L_wait_stream
    v_and_b32 v36, 31, v0
    v_mul_u32_u24 v36, 9, v36
    s_add_u32 s62, s2, 9
    v_add_u32 v36, s62, v36
    v_and_b32 v37, 7, v36
    v_bfe_u32 v36, v36, 3, 5
    v_lshl_add_u32 v36, v37, 5, v36
    v_lshlrev_b32 v36, 7, v36
    v_add_u32 v36, 131072, v36
L_mid:
    s_sleep 4
    ds_read_b32 v16, v10 offset:6276
    s_waitcnt lgkmcnt(0)
    v_cmp_gt_u32 vcc, 4, v16
    s_cbranch_vccz L_mid_ok
    s_sub_u32 s63, s63, 1
    s_cbranch_scc0 L_mid
L_mid_ok:
    buffer_load_dwordx2 v[34:35], v36, s[36:39], 0 offen sc1
    ds_read_b128 v[16:19], v10 offset:6144
    ds_read_b128 v[20:23], v10 offset:6160
    s_waitcnt lgkmcnt(0)
    v_min3_f32 v33, v17, v19, v21
    v_min_f32 v33, v33, v23
    v_sub_f32 v40, v33, v17
    v_sub_f32 v41, v33, v19
    v_sub_f32 v42, v33, v21
    v_sub_f32 v43, v33, v23
    v_exp_f32 v40, v40
    v_exp_f32 v41, v41
    v_exp_f32 v42, v42
    v_exp_f32 v43, v43
    v_mul_f32 v32, v40, v16
    v_fmac_f32 v32, v41, v18
    v_fmac_f32 v32, v42, v20
    v_fmac_f32 v32, v43, v22
    v_min_u32 v32, -2, v32
    v_min_u32 v33, -2, v33
    s_mov_b64 exec, 1
    buffer_store_dwordx2 v[32:33], v10, s[36:39], s42 offen sc1
    s_mov_b64 exec, -1
    s_mov_b32 s16, 0x82838385
    s_mov_b32 s17, 0x8182
    s_mov_b32 s18, 0x3020000
    s_mov_b32 s19, 0x8060503
    s_waitcnt vmcnt(1)
    v_max_u32 v34, v34, v35
    v_cmp_ne_u32 vcc, -1, v34
    s_nop 0
    s_bcnt1_i32_b32 s62, vcc_lo
    s_lshr_b32 s62, s62, 1
    s_min_u32 s62, s62, 15
    s_cmp_ge_u32 s62, 8
    s_cselect_b64 s[16:17], s[18:19], s[16:17]
    s_lshl_b32 s62, s62, 3
    s_lshr_b64 s[16:17], s[16:17], s62
    s_and_b32 s16, s16, 0xff
    v_mov_b32 v34, s16
    ds_write_b32 v10, v34 offset:6284
    s_sleep 127
    s_sleep 127
    s_sleep 127
    s_sleep 127
    s_sleep 127
    s_cmp_ge_u32 s50, 48
    s_cbranch_scc1 L_ready
    v_lshlrev_b32 v39, 9, v0
    s_mov_b32 s20, s57
    s_mov_b32 s21, 0x0c0c0400
    s_mov_b32 s22, 0x04000c0c
    s_mov_b32 s16, 294912
    s_mov_b32 s17, 327680
    s_mov_b32 s18, 360448
    s_mov_b32 s19, 393216
    buffer_load_dwordx4 v[16:19], v39, s[36:39], s16 offen sc1
    buffer_load_dwordx4 v[20:23], v39, s[36:39], s17 offen sc1
    buffer_load_dwordx4 v[24:27], v39, s[36:39], s18 offen sc1
    buffer_load_dwordx4 v[28:31], v39, s[36:39], s19 offen sc1
    s_branch L_pr_w
L_pr:
    s_sleep 32
    s_mov_b64 exec, s[8:9]
    buffer_load_dwordx4 v[16:19], v39, s[36:39], s16 offen sc1
    s_mov_b64 exec, s[10:11]
    buffer_load_dwordx4 v[20:23], v39, s[36:39], s17 offen sc1
    s_mov_b64 exec, s[12:13]
    buffer_load_dwordx4 v[24:27], v39, s[36:39], s18 offen sc1
    s_mov_b64 exec, s[14:15]
    buffer_load_dwordx4 v[28:31], v39, s[36:39], s19 offen sc1
    s_mov_b64 exec, -1
L_pr_w:
    s_waitcnt vmcnt(3)
    v_perm_b32 v34, v17, v16, s21
    v_perm_b32 v36, v19, v18, s22
    v_or_b32 v34, v34, v36
    v_cmp_ne_u32 s[8:9], s20, v34
    s_waitcnt vmcnt(2)
    v_perm_b32 v35, v21, v20, s21
    v_perm_b32 v36, v23, v22, s22
    v_or_b32 v35, v35, v36
    v_cmp_ne_u32 s[10:11], s20, v35
    s_mov_b64 vcc, s[8:9]
    s_waitcnt vmcnt(1)
    v_perm_b32 v34, v25, v24, s21
    v_perm_b32 v36, v27, v26, s22
    v_or_b32 v34, v34, v36
    v_cmp_ne_u32 s[12:13], s20, v34
    s_or_b64 vcc, vcc, s[10:11]
    s_waitcnt vmcnt(0)
    v_perm_b32 v35, v29, v28, s21
    v_perm_b32 v36, v31, v30, s22
    v_or_b32 v35, v35, v36
    v_cmp_ne_u32 s[14:15], s20, v35
    s_or_b64 vcc, vcc, s[12:13]
    s_or_b64 vcc, vcc, s[14:15]
    s_cbranch_scc0 L_pr_ok
    s_sub_u32 s63, s63, 1
    s_cbranch_scc0 L_pr
L_pr_ok:
L_ready:
    buffer_load_dwordx2 v[20:21], v2, s[36:39], 0 offen sc1
    s_branch L_pm_w
L_pm:
    s_sleep 64
    s_mov_b64 exec, s[8:9]
    buffer_load_dwordx2 v[20:21], v2, s[36:39], 0 offen sc1
    s_mov_b64 exec, -1
L_pm_w:
    s_waitcnt vmcnt(0)
    v_max_u32 v22, v20, v21
    v_cmp_eq_u32 s[8:9], -1, v22
    s_nop 0
    s_or_b64 vcc, s[8:9], s[8:9]
    s_cbranch_scc0 L_pm_ok
    s_sub_u32 s63, s63, 1
    s_cbranch_scc0 L_pm
L_pm_ok:
    v_min_f32_dpp v22, v21, v21 quad_perm:[1,0,3,2] row_mask:0xf bank_mask:0xf
    s_nop 1
    v_min_f32_dpp v22, v22, v22 quad_perm:[2,3,0,1] row_mask:0xf bank_mask:0xf
    s_nop 1
    v_min_f32_dpp v22, v22, v22 row_half_mirror row_mask:0xf bank_mask:0xf
    v_sub_f32 v21, v22, v21
    v_sub_f32 v22, v22, v33
    v_exp_f32 v21, v21
    v_exp_f32 v22, v22
    v_mul_f32 v20, v20, v21
    s_nop 1
    v_add_f32_dpp v20, v20, v20 quad_perm:[1,0,3,2] row_mask:0xf bank_mask:0xf
    s_nop 1
    v_add_f32_dpp v20, v20, v20 quad_perm:[2,3,0,1] row_mask:0xf bank_mask:0xf
    s_nop 1
    v_add_f32_dpp v20, v20, v20 row_half_mirror row_mask:0xf bank_mask:0xf
    v_rcp_f32 v20, v20
    s_nop 0
    v_mul_f32 v20, v20, v22
    v_mul_f32 v40, v40, v20
    v_mul_f32 v41, v41, v20
    v_mul_f32 v42, v42, v20
    v_mul_f32 v43, v43, v20
L_wait_stream:
    s_barrier
L_tail:
    s_cmp_lg_u32 s58, 0
    s_cbranch_scc1 L_st1
    ds_read_b64 v[24:25], v11 offset:4096
    ds_read_b64 v[26:27], v11 offset:4608
    ds_read_b64 v[28:29], v11 offset:5120
    ds_read_b64 v[30:31], v11 offset:5632
    s_waitcnt lgkmcnt(3)
    v_mul_f32 v34, v40, v24
    v_mul_f32 v35, v40, v25
    s_waitcnt lgkmcnt(2)
    v_fmac_f32 v34, v41, v26
    v_fmac_f32 v35, v41, v27
    s_waitcnt lgkmcnt(1)
    v_fmac_f32 v34, v42, v28
    v_fmac_f32 v35, v42, v29
    s_waitcnt lgkmcnt(0)
    v_fmac_f32 v34, v43, v30
    v_fmac_f32 v35, v43, v31
    v_min_u32 v34, -2, v34
    v_min_u32 v35, -2, v35
    buffer_store_dwordx2 v[34:35], v11, s[36:39], s53 offen sc1
L_st1:
    buffer_load_dwordx4 v[16:19], v1, s[36:39], 0 offen sc1
    s_branch L_p1_w
L_p1:
    s_mov_b64 exec, s[8:9]
    buffer_load_dwordx4 v[16:19], v1, s[36:39], 0 offen sc1
    s_mov_b64 exec, -1
L_p1_w:
    s_waitcnt vmcnt(0)
    v_max3_u32 v22, v16, v17, v18
    v_max_u32 v22, v22, v19
    v_cmp_eq_u32 s[8:9], -1, v22
    s_nop 0
    s_or_b64 vcc, s[8:9], s[8:9]
    s_cbranch_scc0 L_p1_ok
    s_sub_u32 s63, s63, 1
    s_cbranch_scc0 L_p1
L_p1_ok:
    v_add_f32_dpp v16, v16, v16 quad_perm:[1,0,3,2] row_mask:0xf bank_mask:0xf
    v_add_f32_dpp v17, v17, v17 quad_perm:[1,0,3,2] row_mask:0xf bank_mask:0xf
    v_add_f32_dpp v18, v18, v18 quad_perm:[1,0,3,2] row_mask:0xf bank_mask:0xf
    v_add_f32_dpp v19, v19, v19 quad_perm:[1,0,3,2] row_mask:0xf bank_mask:0xf
    v_add_f32_dpp v16, v16, v16 quad_perm:[2,3,0,1] row_mask:0xf bank_mask:0xf
    v_add_f32_dpp v17, v17, v17 quad_perm:[2,3,0,1] row_mask:0xf bank_mask:0xf
    v_add_f32_dpp v18, v18, v18 quad_perm:[2,3,0,1] row_mask:0xf bank_mask:0xf
    v_add_f32_dpp v19, v19, v19 quad_perm:[2,3,0,1] row_mask:0xf bank_mask:0xf
    v_add_f32_dpp v16, v16, v16 row_half_mirror row_mask:0xf bank_mask:0xf
    v_add_f32_dpp v17, v17, v17 row_half_mirror row_mask:0xf bank_mask:0xf
    v_add_f32_dpp v18, v18, v18 row_half_mirror row_mask:0xf bank_mask:0xf
    v_add_f32_dpp v19, v19, v19 row_half_mirror row_mask:0xf bank_mask:0xf
    s_mov_b32 s10, 0x00ff00ff
    s_mov_b32 s11, 0xff00ff00
    v_cvt_pk_bf16_f32 v16, v16, v16
    v_cvt_pk_bf16_f32 v17, v17, v17
    v_cvt_pk_bf16_f32 v18, v18, v18
    v_cvt_pk_bf16_f32 v19, v19, v19
    v_and_b32 v24, v16, v6
    v_and_b32 v25, v16, v7
    v_and_b32 v26, v16, v8
    v_and_b32 v27, v16, v9
    v_and_b32 v28, v17, v6
    v_and_b32 v29, v17, v7
    v_and_b32 v30, v17, v8
    v_and_b32 v31, v17, v9
    v_and_b32 v32, v18, v6
    v_and_b32 v33, v18, v7
    v_and_b32 v34, v18, v8
    v_and_b32 v35, v18, v9
    v_and_b32 v36, v19, v6
    v_and_b32 v37, v19, v7
    v_and_b32 v38, v19, v8
    v_and_b32 v39, v19, v9
    v_mfma_f32_16x16x32_bf16 v[20:23], v[24:27], v[48:51], 0
    v_mfma_f32_16x16x32_bf16 v[20:23], v[28:31], v[52:55], v[20:23]
    v_mfma_f32_16x16x32_bf16 v[20:23], v[32:35], v[56:59], v[20:23]
    v_mfma_f32_16x16x32_bf16 v[20:23], v[36:39], v[60:63], v[20:23]
    s_mov_b64 exec, s[10:11]
    s_nop 6
    ds_write_b128 v3, v[20:23] offset:6400
    s_mov_b64 exec, -1
    s_waitcnt lgkmcnt(0)
    s_cmp_lg_u32 s55, 0
    s_cbranch_scc1 L_nb1
    s_barrier
L_nb1:
    s_cmp_lg_u32 s58, 0
    s_cbranch_scc1 L_st2
    ds_read2st64_b32 v[16:17], v12 offset0:25 offset1:26
    ds_read2st64_b32 v[18:19], v12 offset0:27 offset1:28
    ds_read2st64_b32 v[20:21], v12 offset0:29 offset1:30
    ds_read2st64_b32 v[22:23], v12 offset0:31 offset1:32
    s_waitcnt lgkmcnt(2)
    v_add_f32 v16, v16, v17
    v_add_f32 v18, v18, v19
    s_waitcnt lgkmcnt(0)
    v_add_f32 v20, v20, v21
    v_add_f32 v22, v22, v23
    v_add_f32 v16, v16, v18
    v_add_f32 v20, v20, v22
    v_add_f32 v16, v16, v20
    v_min_u32 v16, -2, v16
    buffer_store_dword v16, v12, s[36:39], s54 offen sc1
L_st2:
    s_cmp_ge_u32 s50, 28
    s_cbranch_scc1 L_notffn
    buffer_load_dwordx4 v[192:195], v4, s[36:39], 0 offen offset:0 sc1
    buffer_load_dwordx4 v[196:199], v4, s[36:39], 0 offen offset:1024 sc1
    buffer_load_dwordx4 v[200:203], v4, s[36:39], 0 offen offset:2048 sc1
    buffer_load_dwordx4 v[204:207], v4, s[36:39], 0 offen offset:3072 sc1
    buffer_load_dwordx4 v[208:211], v4, s[36:39], s59 offen offset:0 sc1
    buffer_load_dwordx4 v[212:215], v4, s[36:39], s59 offen offset:1024 sc1
    buffer_load_dwordx4 v[216:219], v4, s[36:39], s59 offen offset:2048 sc1
    buffer_load_dwordx4 v[220:223], v4, s[36:39], s59 offen offset:3072 sc1
    buffer_load_dwordx4 v[224:227], v4, s[36:39], s60 offen offset:0 sc1
    buffer_load_dwordx4 v[228:231], v4, s[36:39], s60 offen offset:1024 sc1
    buffer_load_dwordx4 v[232:235], v4, s[36:39], s60 offen offset:2048 sc1
    buffer_load_dwordx4 v[236:239], v4, s[36:39], s60 offen offset:3072 sc1
    buffer_load_dwordx4 v[240:243], v4, s[36:39], s61 offen offset:0 sc1
    buffer_load_dwordx4 v[244:247], v4, s[36:39], s61 offen offset:1024 sc1
    buffer_load_dwordx4 v[248:251], v4, s[36:39], s61 offen offset:2048 sc1
    buffer_load_dwordx4 v[252:255], v4, s[36:39], s61 offen offset:3072 sc1
    s_branch L_p2_w
L_p2:
    s_mov_b64 exec, s[8:9]
    buffer_load_dwordx4 v[192:195], v4, s[36:39], 0 offen offset:0 sc1
    buffer_load_dwordx4 v[196:199], v4, s[36:39], 0 offen offset:1024 sc1
    s_mov_b64 exec, s[10:11]
    buffer_load_dwordx4 v[200:203], v4, s[36:39], 0 offen offset:2048 sc1
    buffer_load_dwordx4 v[204:207], v4, s[36:39], 0 offen offset:3072 sc1
    s_mov_b64 exec, s[12:13]
    buffer_load_dwordx4 v[208:211], v4, s[36:39], s59 offen offset:0 sc1
    buffer_load_dwordx4 v[212:215], v4, s[36:39], s59 offen offset:1024 sc1
    s_mov_b64 exec, s[14:15]
    buffer_load_dwordx4 v[216:219], v4, s[36:39], s59 offen offset:2048 sc1
    buffer_load_dwordx4 v[220:223], v4, s[36:39], s59 offen offset:3072 sc1
    s_mov_b64 exec, s[16:17]
    buffer_load_dwordx4 v[224:227], v4, s[36:39], s60 offen offset:0 sc1
    buffer_load_dwordx4 v[228:231], v4, s[36:39], s60 offen offset:1024 sc1
    s_mov_b64 exec, s[18:19]
    buffer_load_dwordx4 v[232:235], v4, s[36:39], s60 offen offset:2048 sc1
    buffer_load_dwordx4 v[236:239], v4, s[36:39], s60 offen offset:3072 sc1
    s_mov_b64 exec, s[20:21]
    buffer_load_dwordx4 v[240:243], v4, s[36:39], s61 offen offset:0 sc1
    buffer_load_dwordx4 v[244:247], v4, s[36:39], s61 offen offset:1024 sc1
    s_mov_b64 exec, s[22:23]
    buffer_load_dwordx4 v[248:251], v4, s[36:39], s61 offen offset:2048 sc1
    buffer_load_dwordx4 v[252:255], v4, s[36:39], s61 offen offset:3072 sc1
    s_mov_b64 exec, -1
L_p2_w:
    s_waitcnt vmcnt(14)
    v_max3_u32 v16, v192, v193, v194
    v_max3_u32 v16, v16, v195, v196
    v_max3_u32 v16, v16, v197, v198
    v_max_u32 v16, v16, v199
    v_cmp_eq_u32 s[8:9], -1, v16
    s_waitcnt vmcnt(12)
    v_max3_u32 v17, v200, v201, v202
    v_max3_u32 v17, v17, v203, v204
    v_max3_u32 v17, v17, v205, v206
    v_max_u32 v17, v17, v207
    v_cmp_eq_u32 s[10:11], -1, v17
    s_mov_b64 vcc, s[8:9]
    s_waitcnt vmcnt(10)
    v_max3_u32 v16, v208, v209, v210
    v_max3_u32 v16, v16, v211, v212
    v_max3_u32 v16, v16, v213, v214
    v_max_u32 v16, v16, v215
    v_cmp_eq_u32 s[12:13], -1, v16
    s_or_b64 vcc, vcc, s[10:11]
    s_waitcnt vmcnt(8)
    v_max3_u32 v17, v216, v217, v218
    v_max3_u32 v17, v17, v219, v220
    v_max3_u32 v17, v17, v221, v222
    v_max_u32 v17, v17, v223
    v_cmp_eq_u32 s[14:15], -1, v17
    s_or_b64 vcc, vcc, s[12:13]
    s_waitcnt vmcnt(6)
    v_max3_u32 v16, v224, v225, v226
    v_max3_u32 v16, v16, v227, v228
    v_max3_u32 v16, v16, v229, v230
    v_max_u32 v16, v16, v231
    v_cmp_eq_u32 s[16:17], -1, v16
    s_or_b64 vcc, vcc, s[14:15]
    s_waitcnt vmcnt(4)
    v_max3_u32 v17, v232, v233, v234
    v_max3_u32 v17, v17, v235, v236
    v_max3_u32 v17, v17, v237, v238
    v_max_u32 v17, v17, v239
    v_cmp_eq_u32 s[18:19], -1, v17
    s_or_b64 vcc, vcc, s[16:17]
    s_waitcnt vmcnt(2)
    v_max3_u32 v16, v240, v241, v242
    v_max3_u32 v16, v16, v243, v244
    v_max3_u32 v16, v16, v245, v246
    v_max_u32 v16, v16, v247
    v_cmp_eq_u32 s[20:21], -1, v16
    s_or_b64 vcc, vcc, s[18:19]
    s_waitcnt vmcnt(0)
    v_max3_u32 v17, v248, v249, v250
    v_max3_u32 v17, v17, v251, v252
    v_max3_u32 v17, v17, v253, v254
    v_max_u32 v17, v17, v255
    v_cmp_eq_u32 s[22:23], -1, v17
    s_or_b64 vcc, vcc, s[20:21]
    s_or_b64 vcc, vcc, s[22:23]
    s_cbranch_scc0 L_p2_ok
    s_sub_u32 s63, s63, 1
    s_cbranch_scc0 L_p2
L_p2_ok:
    v_pk_add_f32 v[192:193], v[192:193], v[224:225]
    v_pk_add_f32 v[194:195], v[194:195], v[226:227]
    v_pk_add_f32 v[196:197], v[196:197], v[228:229]
    v_pk_add_f32 v[198:199], v[198:199], v[230:231]
    v_pk_add_f32 v[200:201], v[200:201], v[232:233]
    v_pk_add_f32 v[202:203], v[202:203], v[234:235]
    v_pk_add_f32 v[204:205], v[204:205], v[236:237]
    v_pk_add_f32 v[206:207], v[206:207], v[238:239]
    v_pk_add_f32 v[208:209], v[208:209], v[240:241]
    v_pk_add_f32 v[210:211], v[210:211], v[242:243]
    v_pk_add_f32 v[212:213], v[212:213], v[244:245]
    v_pk_add_f32 v[214:215], v[214:215], v[246:247]
    v_pk_add_f32 v[216:217], v[216:217], v[248:249]
    v_pk_add_f32 v[218:219], v[218:219], v[250:251]
    v_pk_add_f32 v[220:221], v[220:221], v[252:253]
    v_pk_add_f32 v[222:223], v[222:223], v[254:255]
    v_pk_add_f32 v[192:193], v[192:193], v[208:209]
    v_pk_add_f32 v[194:195], v[194:195], v[210:211]
    v_pk_add_f32 v[196:197], v[196:197], v[212:213]
    v_pk_add_f32 v[198:199], v[198:199], v[214:215]
    v_pk_add_f32 v[200:201], v[200:201], v[216:217]
    v_pk_add_f32 v[202:203], v[202:203], v[218:219]
    v_pk_add_f32 v[204:205], v[204:205], v[220:221]
    v_pk_add_f32 v[206:207], v[206:207], v[222:223]
    v_pk_add_f32 v[192:193], v[192:193], v[200:201]
    v_pk_add_f32 v[194:195], v[194:195], v[202:203]
    v_pk_add_f32 v[196:197], v[196:197], v[204:205]
    v_pk_add_f32 v[198:199], v[198:199], v[206:207]
    v_pk_add_f32 v[192:193], v[192:193], v[196:197]
    v_pk_add_f32 v[194:195], v[194:195], v[198:199]
    s_nop 1
    v_permlane32_swap_b32 v192, v194
    v_permlane32_swap_b32 v193, v195
    v_add_f32 v16, v192, v194
    v_add_f32 v17, v193, v195
    v_cvt_pk_bf16_f32 v16, 0, v16
    v_cvt_pk_bf16_f32 v17, 0, v17
    v_add_f32 v16, v16, v13
    v_add_f32 v17, v17, v14
    v_cvt_pk_bf16_f32 v16, v16, v17
    ds_write_b32 v5, v16 offset:8448
    s_waitcnt lgkmcnt(0)
    s_cmp_lg_u32 s55, 0
    s_cbranch_scc1 L_nb2
    s_barrier
L_nb2:
    ds_read_b128 v[20:23], v47 offset:8448
    s_waitcnt lgkmcnt(0)
    v_lshlrev_b32 v24, 16, v20
    v_and_b32 v25, 0xffff0000, v20
    v_lshlrev_b32 v26, 16, v21
    v_and_b32 v27, 0xffff0000, v21
    v_lshlrev_b32 v28, 16, v22
    v_and_b32 v29, 0xffff0000, v22
    v_lshlrev_b32 v30, 16, v23
    v_and_b32 v31, 0xffff0000, v23
    v_add_f32 v32, v24, v25
    v_add_f32 v33, v26, v27
    v_add_f32 v34, v28, v29
    v_add_f32 v35, v30, v31
    v_add_f32 v32, v32, v33
    v_add_f32 v34, v34, v35
    v_add_f32 v32, v32, v34
    v_mov_b32 v35, 0x3b000000
    s_nop 0
    v_add_f32_dpp v32, v32, v32 row_ror:8 row_mask:0xf bank_mask:0xf
    s_nop 1
    v_add_f32_dpp v32, v32, v32 row_ror:4 row_mask:0xf bank_mask:0xf
    s_nop 1
    v_add_f32_dpp v32, v32, v32 row_ror:2 row_mask:0xf bank_mask:0xf
    s_nop 1
    v_add_f32_dpp v32, v32, v32 row_ror:1 row_mask:0xf bank_mask:0xf
    s_nop 1
    v_add_f32_dpp v32, v32, v32 row_bcast:15 row_mask:0xa bank_mask:0xf
    s_nop 1
    v_add_f32_dpp v32, v32, v32 row_bcast:31 row_mask:0xc bank_mask:0xf
    s_nop 0
    v_readlane_b32 s62, v32, 63
    s_nop 1
    v_mul_f32 v33, s62, v35
    v_sub_f32 v34, v24, v33
    v_mul_f32 v32, v34, v34
    v_sub_f32 v34, v25, v33
    v_fmac_f32 v32, v34, v34
    v_sub_f32 v34, v26, v33
    v_fmac_f32 v32, v34, v34
    v_sub_f32 v34, v27, v33
    v_fmac_f32 v32, v34, v34
    v_sub_f32 v34, v28, v33
    v_fmac_f32 v32, v34, v34
    v_sub_f32 v34, v29, v33
    v_fmac_f32 v32, v34, v34
    v_sub_f32 v34, v30, v33
    v_fmac_f32 v32, v34, v34
    v_sub_f32 v34, v31, v33
    v_fmac_f32 v32, v34, v34
    v_cvt_pk_bf16_f32 v33, 0, v33
    v_sub_f32 v24, v24, v33
    v_sub_f32 v25, v25, v33
    v_add_f32_dpp v32, v32, v32 row_ror:8 row_mask:0xf bank_mask:0xf
    v_sub_f32 v26, v26, v33
    v_sub_f32 v27, v27, v33
    v_add_f32_dpp v32, v32, v32 row_ror:4 row_mask:0xf bank_mask:0xf
    v_sub_f32 v28, v28, v33
    v_sub_f32 v29, v29, v33
    v_add_f32_dpp v32, v32, v32 row_ror:2 row_mask:0xf bank_mask:0xf
    v_sub_f32 v30, v30, v33
    v_sub_f32 v31, v31, v33
    v_add_f32_dpp v32, v32, v32 row_ror:1 row_mask:0xf bank_mask:0xf
    v_cvt_pk_bf16_f32 v24, 0, v24
    v_cvt_pk_bf16_f32 v25, 0, v25
    v_add_f32_dpp v32, v32, v32 row_bcast:15 row_mask:0xa bank_mask:0xf
    v_cvt_pk_bf16_f32 v26, 0, v26
    v_cvt_pk_bf16_f32 v27, 0, v27
    v_add_f32_dpp v32, v32, v32 row_bcast:31 row_mask:0xc bank_mask:0xf
    s_nop 0
    v_readlane_b32 s62, v32, 63
    s_nop 1
    v_mul_f32 v32, s62, v35
    v_cvt_pk_bf16_f32 v32, 0, v32
    v_add_f32 v32, 0x3727c5ac, v32
    v_cvt_pk_bf16_f32 v32, 0, v32
    v_sqrt_f32 v32, v32
    s_nop 0
    v_cvt_pk_bf16_f32 v32, 0, v32
    v_rcp_f32 v32, v32
    v_cvt_pk_bf16_f32 v28, 0, v28
    v_cvt_pk_bf16_f32 v29, 0, v29
    v_cvt_pk_bf16_f32 v30, 0, v30
    v_cvt_pk_bf16_f32 v31, 0, v31
    v_mul_f32 v24, v24, v32
    v_mul_f32 v25, v25, v32
    v_mul_f32 v26, v26, v32
    v_mul_f32 v27, v27, v32
    v_mul_f32 v28, v28, v32
    v_mul_f32 v29, v29, v32
    v_mul_f32 v30, v30, v32
    v_mul_f32 v31, v31, v32
    v_cvt_pk_bf16_f32 v20, v24, v25
    v_cvt_pk_bf16_f32 v21, v26, v27
    v_cvt_pk_bf16_f32 v22, v28, v29
    v_cvt_pk_bf16_f32 v23, v30, v31
    ds_write_b128 v47, v[20:23] offset:9472
    s_waitcnt lgkmcnt(0)
    ds_read_b128 v[192:195], v15 offset:9472
    ds_read_b128 v[196:199], v15 offset:9536
    ds_read_b128 v[200:203], v15 offset:9600
    ds_read_b128 v[204:207], v15 offset:9664
    ds_read_b128 v[208:211], v15 offset:9728
    ds_read_b128 v[212:215], v15 offset:9792
    ds_read_b128 v[216:219], v15 offset:9856
    ds_read_b128 v[220:223], v15 offset:9920
    ds_read_b128 v[224:227], v15 offset:9984
    ds_read_b128 v[228:231], v15 offset:10048
    ds_read_b128 v[232:235], v15 offset:10112
    ds_read_b128 v[236:239], v15 offset:10176
    s_waitcnt lgkmcnt(11)
    v_mfma_f32_16x16x32_bf16 v[16:19], v[192:195], v[64:67], 0
    ds_read_b128 v[240:243], v15 offset:10240
    s_waitcnt lgkmcnt(11)
    v_mfma_f32_16x16x32_bf16 v[16:19], v[196:199], v[68:71], v[16:19]
    ds_read_b128 v[244:247], v15 offset:10304
    s_waitcnt lgkmcnt(11)
    v_mfma_f32_16x16x32_bf16 v[16:19], v[200:203], v[72:75], v[16:19]
    ds_read_b128 v[248:251], v15 offset:10368
    s_waitcnt lgkmcnt(11)
    v_mfma_f32_16x16x32_bf16 v[16:19], v[204:207], v[76:79], v[16:19]
    ds_read_b128 v[252:255], v15 offset:10432
    s_waitcnt lgkmcnt(11)
    v_mfma_f32_16x16x32_bf16 v[16:19], v[208:211], v[80:83], v[16:19]
    s_waitcnt lgkmcnt(10)
    v_mfma_f32_16x16x32_bf16 v[16:19], v[212:215], v[84:87], v[16:19]
    s_waitcnt lgkmcnt(9)
    v_mfma_f32_16x16x32_bf16 v[16:19], v[216:219], v[88:91], v[16:19]
    s_waitcnt lgkmcnt(8)
    v_mfma_f32_16x16x32_bf16 v[16:19], v[220:223], v[92:95], v[16:19]
    s_waitcnt lgkmcnt(7)
    v_mfma_f32_16x16x32_bf16 v[16:19], v[224:227], v[96:99], v[16:19]
    s_waitcnt lgkmcnt(6)
    v_mfma_f32_16x16x32_bf16 v[16:19], v[228:231], v[100:103], v[16:19]
    s_waitcnt lgkmcnt(5)
    v_mfma_f32_16x16x32_bf16 v[16:19], v[232:235], v[104:107], v[16:19]
    s_waitcnt lgkmcnt(4)
    v_mfma_f32_16x16x32_bf16 v[16:19], v[236:239], v[108:111], v[16:19]
    s_waitcnt lgkmcnt(3)
    v_mfma_f32_16x16x32_bf16 v[16:19], v[240:243], v[112:115], v[16:19]
    s_waitcnt lgkmcnt(2)
    v_mfma_f32_16x16x32_bf16 v[16:19], v[244:247], v[116:119], v[16:19]
    s_waitcnt lgkmcnt(1)
    v_mfma_f32_16x16x32_bf16 v[16:19], v[248:251], v[120:123], v[16:19]
    s_waitcnt lgkmcnt(0)
    v_mfma_f32_16x16x32_bf16 v[16:19], v[252:255], v[124:127], v[16:19]
    s_nop 7
    v_cvt_pk_bf16_f32 v16, 0, v16
    v_mul_f32 v17, 0xbfb8aa3b, v16
    v_exp_f32 v17, v17
    s_nop 0
    v_add_f32 v17, 1.0, v17
    v_rcp_f32 v17, v17
    s_nop 0
    v_mul_f32 v16, v16, v17
    v_cvt_pk_bf16_f32 v16, v16, v16
    ds_write_b16 v46, v16 offset:10496
    s_waitcnt lgkmcnt(0)
    s_cmp_lg_u32 s55, 0
    s_cbranch_scc1 L_nb3
    s_barrier
L_nb3:
    ds_read_b128 v[20:23], v15 offset:10496
    ds_read_b128 v[24:27], v15 offset:10560
    s_waitcnt lgkmcnt(1)
    v_mfma_f32_16x16x32_bf16 v[192:195], v[20:23], v[128:131], 0
    v_mfma_f32_16x16x32_bf16 v[196:199], v[20:23], v[136:139], 0
    v_mfma_f32_16x16x32_bf16 v[200:203], v[20:23], v[144:147], 0
    v_mfma_f32_16x16x32_bf16 v[204:207], v[20:23], v[152:155], 0
    v_mfma_f32_16x16x32_bf16 v[208:211], v[20:23], v[160:163], 0
    v_mfma_f32_16x16x32_bf16 v[212:215], v[20:23], v[168:171], 0
    v_mfma_f32_16x16x32_bf16 v[216:219], v[20:23], v[176:179], 0
    v_mfma_f32_16x16x32_bf16 v[220:223], v[20:23], v[184:187], 0
    s_waitcnt lgkmcnt(0)
    v_mfma_f32_16x16x32_bf16 v[192:195], v[24:27], v[132:135], v[192:195]
    v_mfma_f32_16x16x32_bf16 v[196:199], v[24:27], v[140:143], v[196:199]
    v_mfma_f32_16x16x32_bf16 v[200:203], v[24:27], v[148:151], v[200:203]
    v_mfma_f32_16x16x32_bf16 v[204:207], v[24:27], v[156:159], v[204:207]
    v_mfma_f32_16x16x32_bf16 v[208:211], v[24:27], v[164:167], v[208:211]
    v_mfma_f32_16x16x32_bf16 v[212:215], v[24:27], v[172:175], v[212:215]
    v_mfma_f32_16x16x32_bf16 v[216:219], v[24:27], v[180:183], v[216:219]
    v_mfma_f32_16x16x32_bf16 v[220:223], v[24:27], v[188:191], v[220:223]
    s_nop 0
    v_mov_b32_dpp v16, v192 quad_perm:[0,1,2,3] row_mask:0x1 bank_mask:0xf
    v_mov_b32_dpp v17, v196 quad_perm:[0,1,2,3] row_mask:0x1 bank_mask:0xf
    s_nop 0
    v_mov_b32_dpp v16, v200 quad_perm:[0,1,2,3] row_mask:0x2 bank_mask:0xf
    v_mov_b32_dpp v17, v204 quad_perm:[0,1,2,3] row_mask:0x2 bank_mask:0xf
    s_nop 0
    v_mov_b32_dpp v16, v208 quad_perm:[0,1,2,3] row_mask:0x4 bank_mask:0xf
    v_mov_b32_dpp v17, v212 quad_perm:[0,1,2,3] row_mask:0x4 bank_mask:0xf
    s_nop 0
    v_mov_b32_dpp v16, v216 quad_perm:[0,1,2,3] row_mask:0x8 bank_mask:0xf
    v_mov_b32_dpp v17, v220 quad_perm:[0,1,2,3] row_mask:0x8 bank_mask:0xf
    v_min_u32 v16, -2, v16
    v_min_u32 v17, -2, v17
    buffer_store_dwordx2 v[16:17], v11, s[36:39], s52 offen sc1
    s_branch L_tail_done
L_notffn:
    s_cmp_lg_u32 s58, 2
    s_cbranch_scc1 L_tail_done
    s_cmp_ge_u32 s51, 16
    s_cbranch_scc1 L_tail_done
    buffer_load_dwordx4 v[16:19], v4, s[36:39], 0 offen sc1
    buffer_load_dwordx4 v[20:23], v4, s[36:39], s59 offen sc1
    buffer_load_dwordx4 v[24:27], v4, s[36:39], s60 offen sc1
    buffer_load_dwordx4 v[28:31], v4, s[36:39], s61 offen sc1
    s_branch L_p3_w
L_p3:
    s_mov_b64 exec, s[8:9]
    buffer_load_dwordx4 v[16:19], v4, s[36:39], 0 offen sc1
    s_mov_b64 exec, s[10:11]
    buffer_load_dwordx4 v[20:23], v4, s[36:39], s59 offen sc1
    s_mov_b64 exec, s[12:13]
    buffer_load_dwordx4 v[24:27], v4, s[36:39], s60 offen sc1
    s_mov_b64 exec, s[14:15]
    buffer_load_dwordx4 v[28:31], v4, s[36:39], s61 offen sc1
    s_mov_b64 exec, -1
L_p3_w:
    s_waitcnt vmcnt(3)
    v_max3_u32 v32, v16, v17, v18
    v_max_u32 v32, v32, v19
    v_cmp_eq_u32 s[8:9], -1, v32
    s_waitcnt vmcnt(2)
    v_max3_u32 v33, v20, v21, v22
    v_max_u32 v33, v33, v23
    v_cmp_eq_u32 s[10:11], -1, v33
    s_mov_b64 vcc, s[8:9]
    s_waitcnt vmcnt(1)
    v_max3_u32 v32, v24, v25, v26
    v_max_u32 v32, v32, v27
    v_cmp_eq_u32 s[12:13], -1, v32
    s_or_b64 vcc, vcc, s[10:11]
    s_waitcnt vmcnt(0)
    v_max3_u32 v33, v28, v29, v30
    v_max_u32 v33, v33, v31
    v_cmp_eq_u32 s[14:15], -1, v33
    s_or_b64 vcc, vcc, s[12:13]
    s_or_b64 vcc, vcc, s[14:15]
    s_cbranch_scc0 L_p3_ok
    s_sub_u32 s63, s63, 1
    s_cbranch_scc0 L_p3
L_p3_ok:
    v_pk_add_f32 v[16:17], v[16:17], v[24:25]
    v_pk_add_f32 v[18:19], v[18:19], v[26:27]
    v_pk_add_f32 v[20:21], v[20:21], v[28:29]
    v_pk_add_f32 v[22:23], v[22:23], v[30:31]
    v_pk_add_f32 v[16:17], v[16:17], v[20:21]
    v_pk_add_f32 v[18:19], v[18:19], v[22:23]
    s_nop 1
    v_permlane32_swap_b32 v16, v18
    v_permlane32_swap_b32 v17, v19
    v_add_f32 v16, v16, v18
    v_add_f32 v17, v17, v19
    s_nop 1
    v_permlane16_swap_b32 v16, v17
    v_add_f32 v16, v16, v17
    s_nop 1
    v_add_f32_dpp v16, v16, v16 row_ror:8 row_mask:0xf bank_mask:0xf
    v_cvt_pk_bf16_f32 v16, 0, v16
    v_add_f32 v16, v16, v13
    v_cvt_pk_bf16_f32 v34, 0, v16
    buffer_load_dwordx4 v[16:19], v5, s[36:39], 0 offen sc1
    buffer_load_dwordx4 v[20:23], v5, s[36:39], s59 offen sc1
    buffer_load_dwordx4 v[24:27], v5, s[36:39], s60 offen sc1
    buffer_load_dwordx4 v[28:31], v46, s[36:39], s61 offen sc1
    s_branch L_p4_w
L_p4:
    s_mov_b64 exec, s[8:9]
    buffer_load_dwordx4 v[16:19], v5, s[36:39], 0 offen sc1
    s_mov_b64 exec, s[10:11]
    buffer_load_dwordx4 v[20:23], v5, s[36:39], s59 offen sc1
    s_mov_b64 exec, s[12:13]
    buffer_load_dwordx4 v[24:27], v5, s[36:39], s60 offen sc1
    s_mov_b64 exec, s[14:15]
    buffer_load_dwordx4 v[28:31], v46, s[36:39], s61 offen sc1
    s_mov_b64 exec, -1
L_p4_w:
    s_waitcnt vmcnt(3)
    v_max3_u32 v32, v16, v17, v18
    v_max_u32 v32, v32, v19
    v_cmp_eq_u32 s[8:9], -1, v32
    s_waitcnt vmcnt(2)
    v_max3_u32 v33, v20, v21, v22
    v_max_u32 v33, v33, v23
    v_cmp_eq_u32 s[10:11], -1, v33
    s_mov_b64 vcc, s[8:9]
    s_waitcnt vmcnt(1)
    v_max3_u32 v32, v24, v25, v26
    v_max_u32 v32, v32, v27
    v_cmp_eq_u32 s[12:13], -1, v32
    s_or_b64 vcc, vcc, s[10:11]
    s_waitcnt vmcnt(0)
    v_max3_u32 v33, v28, v29, v30
    v_max_u32 v33, v33, v31
    v_cmp_eq_u32 s[14:15], -1, v33
    s_or_b64 vcc, vcc, s[12:13]
    s_or_b64 vcc, vcc, s[14:15]
    s_cbranch_scc0 L_p4_ok
    s_sub_u32 s63, s63, 1
    s_cbranch_scc0 L_p4
L_p4_ok:
    v_pk_add_f32 v[16:17], v[16:17], v[24:25]
    v_pk_add_f32 v[18:19], v[18:19], v[26:27]
    v_pk_add_f32 v[20:21], v[20:21], v[28:29]
    v_pk_add_f32 v[22:23], v[22:23], v[30:31]
    v_pk_add_f32 v[16:17], v[16:17], v[20:21]
    v_pk_add_f32 v[18:19], v[18:19], v[22:23]
    s_nop 1
    v_permlane32_swap_b32 v16, v18
    v_permlane32_swap_b32 v17, v19
    v_add_f32 v16, v16, v18
    v_add_f32 v17, v17, v19
    s_nop 1
    v_permlane16_swap_b32 v16, v17
    v_add_f32 v16, v16, v17
    s_nop 1
    v_add_f32_dpp v16, v16, v16 row_ror:8 row_mask:0xf bank_mask:0xf
    v_cvt_pk_bf16_f32 v16, 0, v16
    v_add_f32 v16, v16, v34
    v_cvt_pk_bf16_f32 v16, v16, v16
    s_mov_b32 exec_lo, 0x00ff00ff
    s_mov_b32 exec_hi, 0x00ff00ff
    buffer_store_short v16, v15, s[28:31], 0 offen
    v_mov_b32 v17, s57
    s_mov_b32 s62, 425984
    s_mov_b64 exec, 1
    buffer_store_dword v17, v10, s[36:39], s62 offen
    s_branch L_tail_done
L_hend:
L_end:
    s_endpgm
.section .rodata,"a"
.p2align 6
.amdhsa_kernel sequential_preLN__mha_block_cached__dense_activation_silu__decode_kernel
  .amdhsa_next_free_vgpr 256
  .amdhsa_next_free_sgpr 72
  .amdhsa_accum_offset 256
  .amdhsa_group_segment_fixed_size 0
  .amdhsa_kernarg_size 88
  .amdhsa_user_sgpr_count 2
  .amdhsa_user_sgpr_kernarg_segment_ptr 1
  .amdhsa_system_sgpr_workgroup_id_x 1
  .amdhsa_float_denorm_mode_32 3
.end_amdhsa_kernel
```
